```python
import torch

def _softmax(x, axis=-1):
    return torch.softmax(x, dim=axis)
def _gelu(x):
    return torch.nn.functional.gelu(x, approximate="tanh")
def _silu(x):
    return torch.nn.functional.silu(x)
def _sigmoid(x):
    return torch.sigmoid(x)
def _layernorm(x, axis=-1, eps=1e-5):
    m = x.mean(dim=axis, keepdim=True)
    v = x.var(dim=axis, keepdim=True, unbiased=False)
    return (x - m) / torch.sqrt(v + eps)
def _scatter_add(tgt, idx, src, axis=0):
    return tgt.clone().index_add_(axis, idx, src)
def _segment_sum(src, seg, n):
    out = torch.zeros((n,) + src.shape[1:], dtype=src.dtype)
    return out.index_add_(0, seg, src)
def _pad(x, pw):
    flat = tuple(v for pair in reversed(pw) for v in pair)
    return torch.nn.functional.pad(x, flat)

kernel_name = 'gated_mix__gqa_block_cached__compressed_kv_cla__decode'

def setup_inputs():

    _w = (lambda a: (lambda t: t.to(torch.bfloat16) if t.is_floating_point() else t)(torch.as_tensor(a)))
    def _A_setup():
        B, Sq, D = 2, 1, 576
        Hq, Hkv, Sk, Dh = 32, 16, 8192, 128
        assert Hq % Hkv == 0, (Hq, Hkv)
        return {
            "x": _w((lambda *s: torch.randn(*s, dtype=torch.bfloat16) * 0.05)(B, Sq, D)),
            "k_cache": _w((lambda *s: torch.randn(*s, dtype=torch.bfloat16) * 6.4)(B, Hkv, Sk, Dh)),
            "v_cache": _w((lambda *s: torch.randn(*s, dtype=torch.bfloat16) * 0.8)(B, Hkv, Sk, Dh)),
            "wq": _w((lambda *s: torch.randn(*s, dtype=torch.bfloat16) * 6.4)(D, Hq * Dh) * (D ** -0.5)),
            "wo": _w((lambda *s: torch.randn(*s, dtype=torch.bfloat16) * 0.8)(Hq * Dh, D) * ((Hq * Dh) ** -0.5)),
        }
    _A_in = _A_setup()

    def _B_setup():
        B, H, Sq, Sk, D, M = 2, 32, 1, 8192, 128, 576
        Dc = 4 * D
        return {
            "x": _w((lambda *s: torch.randn(*s, dtype=torch.bfloat16) * 0.05)(B, Sq, M)),
            "c_kv": _w((lambda *s: torch.randn(*s, dtype=torch.bfloat16) * 1.6)(B, Sk, Dc)),
            "w_q": _w((lambda *s: torch.randn(*s, dtype=torch.bfloat16) * 3.2)(M, H, D) * (M ** -0.5)),
            "w_uk": _w((lambda *s: torch.randn(*s, dtype=torch.bfloat16) * 3.2)(Dc, H, D) * (Dc ** -0.5)),
            "w_uv": _w((lambda *s: torch.randn(*s, dtype=torch.bfloat16) * 1.6)(Dc, H, D) * (Dc ** -0.5)),
            "w_o": _w((lambda *s: torch.randn(*s, dtype=torch.bfloat16) * 1.6)(H, D, M) * ((H * D) ** -0.5)),
        }
    _B_in = _B_setup()

    return {
        "A_x": _A_in["x"],
        "A_k_cache": _A_in["k_cache"],
        "A_v_cache": _A_in["v_cache"],
        "A_wq": _A_in["wq"],
        "A_wo": _A_in["wo"],
        "B_x": _B_in["x"],
        "B_c_kv": _B_in["c_kv"],
        "B_w_q": _B_in["w_q"],
        "B_w_uk": _B_in["w_uk"],
        "B_w_uv": _B_in["w_uv"],
        "B_w_o": _B_in["w_o"],
        "gate_w": _w((lambda *s: torch.randn(*s, dtype=torch.bfloat16) * 0.05)(576) * 16.0),
    }

def reference(A_x, A_k_cache, A_v_cache, A_wq, A_wo, B_x, B_c_kv, B_w_q, B_w_uk, B_w_uv, B_w_o, gate_w):
    def _A_ref(x, k_cache, v_cache, wq, wo):
        B, Sq, D = x.shape
        Hq, Dh = 32, 128
        Hkv = k_cache.shape[1]
        rep = Hq // Hkv
        q = (lambda x, *d: x.permute(*d))((x @ wq).reshape(B, Sq, Hq, Dh), 0, 2, 1, 3)
        k = (lambda x, n, axis: torch.repeat_interleave(x, n, dim=axis))(k_cache, rep, axis=1)
        v = (lambda x, n, axis: torch.repeat_interleave(x, n, dim=axis))(v_cache, rep, axis=1)
        scores = torch.einsum("bhqd,bhkd->bhqk", q, k) * (Dh ** -0.5)
        p = _softmax(scores, axis=-1)
        o = torch.einsum("bhqk,bhkd->bhqd", p, v)
        return (lambda x, *d: x.permute(*d))(o, 0, 2, 1, 3).reshape(B, Sq, Hq * Dh) @ wo

    def _B_ref(x, c_kv, w_q, w_uk, w_uv, w_o):
        B, Sq, M = x.shape[0], x.shape[1], x.shape[2]
        Sk = c_kv.shape[1]
        H, D = w_q.shape[1], w_q.shape[2]
        q = torch.einsum("bqm,mhd->bhqd", x, w_q)
        k = torch.einsum("bkc,chd->bhkd", c_kv, w_uk)
        v = torch.einsum("bkc,chd->bhkd", c_kv, w_uv)
        scores = torch.einsum("bhqd,bhkd->bhqk", q, k) * (D ** -0.5)
        off = Sk - Sq
        qi = torch.arange(Sq)[:, None]
        kj = torch.arange(Sk)[None, :]
        cmask = kj <= (qi + off)
        scores = torch.where(cmask[None, None], scores, -1e9)
        p = _softmax(scores, axis=-1)
        ctx = torch.einsum("bhqk,bhkd->bhqd", p, v)
        return torch.einsum("bhqd,hdm->bqm", ctx, w_o)

    x = A_x
    g = _sigmoid((x * gate_w).sum(-1, keepdims=True))
    a = _A_ref(x, A_k_cache, A_v_cache, A_wq, A_wo)
    b = _B_ref(x, B_c_kv, B_w_q, B_w_uk, B_w_uv, B_w_o)
    return g * a + (1 - g) * b
```

```asm
; @launch grid=(256,1,1) block=(512,1,1) lds=163840
.amdgcn_target "amdgcn-amd-amdhsa--gfx950"
.text
.globl gated_mix__gqa_block_cached__compressed_kv_cla__decode_kernel
.p2align 8
.type gated_mix__gqa_block_cached__compressed_kv_cla__decode_kernel,@function
gated_mix__gqa_block_cached__compressed_kv_cla__decode_kernel:
    s_cmp_ge_u32 s2, 256
    s_cbranch_scc1 L_end
    s_load_dwordx2 s[4:5], s[0:1], 0
    s_load_dwordx2 s[8:9], s[0:1], 112
    s_cmp_lt_u32 s2, 64
    s_cbranch_scc1 L_B
    s_load_dwordx2 s[24:25], s[0:1], 56
    s_load_dwordx2 s[12:13], s[0:1], 24
    s_load_dwordx2 s[16:17], s[0:1], 8
    s_load_dwordx2 s[28:29], s[0:1], 64
    s_load_dwordx2 s[20:21], s[0:1], 16
    s_mov_b32 s6, 2304
    s_mov_b32 s7, 0x20000
    s_mov_b32 s26, 4718592
    s_mov_b32 s27, 0x20000
    s_mov_b32 s14, 4718592
    s_mov_b32 s15, 0x20000
    v_lshrrev_b32 v2, 6, v0
    v_and_b32 v1, 63, v0
    v_readfirstlane_b32 s44, v2
    v_lshrrev_b32 v2, 4, v1
    v_and_b32 v3, 15, v1
    s_sub_u32 s49, s2, 64
    s_and_b32 s52, s49, 7
    s_lshr_b32 s60, s49, 3
    s_cmp_ge_u32 s60, 12
    s_cselect_b32 s50, 1, 0
    s_cselect_b32 s51, 12, 0
    s_sub_u32 s60, s60, s51
    s_lshl_b32 s57, s52, 1
    s_add_u32 s57, s57, s50
    s_lshl_b32 s50, s50, 3
    s_add_u32 s52, s52, s50
    s_cmp_ge_u32 s60, 6
    s_cselect_b32 s58, 1, 0
    s_cselect_b32 s51, 6, 0
    s_sub_u32 s59, s60, s51
    s_lshl_b32 s61, s58, 4
    s_add_u32 s61, s61, s52
    s_lshl_b32 s61, s61, 21
    s_lshl_b32 s52, s52, 1
    s_add_u32 s52, s52, s58
    v_lshlrev_b32 v16, 4, v3
    v_lshl_or_b32 v16, v2, 15, v16
    v_bfe_u32 v17, v1, 2, 1
    v_mul_u32_u24 v17, 1152, v17
    v_lshl_add_u32 v17, v2, 3, v17
    s_cmp_ge_u32 s44, 6
    s_cbranch_scc1 L_A_w67
    s_mul_i32 s49, s59, 96
    s_lshl_b32 s50, s44, 4
    s_add_u32 s49, s49, s50
    s_lshl_b32 s50, s49, 1
    s_lshl_b32 s49, s49, 13
    s_lshl_b32 s51, s52, 8
    s_add_u32 s51, s51, s49
    s_setprio 3
    s_waitcnt lgkmcnt(0)
    buffer_load_dwordx4 v[56:59], v16, s[24:27], s51 offen nt
    s_add_u32 s51, s51, 8192
    buffer_load_dwordx4 v[60:63], v16, s[24:27], s51 offen nt
    s_add_u32 s51, s51, 8192
    buffer_load_dwordx4 v[64:67], v16, s[24:27], s51 offen nt
    s_add_u32 s51, s51, 8192
    buffer_load_dwordx4 v[68:71], v16, s[24:27], s51 offen nt
    s_add_u32 s51, s51, 4294942720
    buffer_load_dwordx2 v[44:45], v17, s[4:7], s50 offen
    s_setprio 1
    buffer_load_dwordx4 v[72:75], v16, s[12:15], s51 offen nt
    s_add_u32 s51, s51, 8192
    buffer_load_dwordx4 v[76:79], v16, s[12:15], s51 offen nt
    s_add_u32 s51, s51, 8192
    buffer_load_dwordx4 v[80:83], v16, s[12:15], s51 offen nt
    s_add_u32 s51, s51, 8192
    buffer_load_dwordx4 v[84:87], v16, s[12:15], s51 offen nt
    s_setprio 0
    s_mov_b32 s10, 268435456
    s_mov_b32 s11, 0x20000
    s_mov_b32 s18, 67108864
    s_mov_b32 s19, 0x20000
    s_mov_b32 s30, 4194304
    s_mov_b32 s31, 0x20000
    s_mov_b32 s22, 67108864
    s_mov_b32 s23, 0x20000
    s_mov_b32 s45, 0x05040100
    s_mov_b32 s46, 0x07060302
    s_mov_b32 s47, 0x3e0293ee
    v_lshlrev_b32 v8, 4, v1
    v_mov_b32 v248, 144384
    s_lshl_b32 s38, s59, 2
    s_lshr_b32 s38, 0x665555, s38
    s_and_b32 s38, s38, 15
    s_mov_b32 s49, 131072
    s_mov_b32 s39, 4294836224
    s_cmp_eq_u32 s59, 1
    s_cselect_b32 s49, 458752, s49
    s_cselect_b32 s39, 4294529024, s39
    s_cmp_eq_u32 s59, 2
    s_cselect_b32 s49, 786432, s49
    s_cselect_b32 s39, 4294221824, s39
    s_cmp_eq_u32 s59, 3
    s_cselect_b32 s49, 1114112, s49
    s_cselect_b32 s39, 4293914624, s39
    s_cmp_eq_u32 s59, 4
    s_cselect_b32 s49, 1441792, s49
    s_cselect_b32 s39, 4293607424, s39
    s_cmp_eq_u32 s59, 5
    s_cselect_b32 s49, 1769472, s49
    s_cselect_b32 s39, 4293304320, s39
    s_add_u32 s61, s61, s49
    s_lshl_b32 s49, s44, 13
    s_add_u32 s61, s61, s49
    s_add_u32 s39, s39, s61
    s_lshl_b32 s49, s44, 12
    s_sub_u32 s61, s61, s49
    s_cmp_lt_u32 s59, 4
    s_cselect_b32 s49, 2, 4
    s_cmp_lt_u32 s44, s49
    s_cselect_b32 s63, 6, 5
    s_cmp_eq_u32 s44, 7
    s_cselect_b32 s63, 5, s63
    s_lshl_b32 s50, s44, 2
    s_lshr_b32 s50, 0x1763245, s50
    s_and_b32 s50, s50, 7
    s_cmp_lt_u32 s59, 4
    s_cselect_b32 s49, 4, 8
    s_cmp_lt_u32 s50, s38
    s_cselect_b32 s63, 6, 5
    s_lshl_b32 s50, s50, 12
    s_lshl_b32 s49, s44, 13
    s_sub_u32 s50, s50, s49
    s_add_u32 s39, s39, s50
    s_lshl_b32 s62, s44, 14
    s_mov_b32 s42, 0
    v_lshlrev_b32 v18, 2, v2
    v_xor_b32 v18, v18, v3
    v_lshlrev_b32 v18, 4, v18
    v_lshl_or_b32 v4, v2, 8, v18
    v_xor_b32 v5, 16, v4
    v_xor_b32 v6, 32, v4
    v_xor_b32 v7, 48, v4
    s_barrier
    v_bfe_u32 v18, v1, 4, 1
    v_lshlrev_b32 v18, 9, v18
    v_lshl_add_u32 v18, v3, 5, v18
    s_lshl_b32 s51, s44, 10
    s_add_u32 s51, s51, 131072
    v_add_u32 v18, s51, v18
    v_mov_b32 v19, 1
    s_waitcnt vmcnt(4)
    v_perm_b32 v48, v60, v56, s45
    v_perm_b32 v49, v68, v64, s45
    v_perm_b32 v52, v60, v56, s46
    v_perm_b32 v53, v68, v64, s46
    v_mfma_f32_16x16x16_bf16 v[88:91], v[44:45], v[48:49], 0
    v_perm_b32 v48, v61, v57, s45
    v_perm_b32 v49, v69, v65, s45
    v_mfma_f32_16x16x16_bf16 v[92:95], v[44:45], v[52:53], 0
    v_perm_b32 v52, v61, v57, s46
    v_perm_b32 v53, v69, v65, s46
    v_mfma_f32_16x16x16_bf16 v[96:99], v[44:45], v[48:49], 0
    v_perm_b32 v48, v62, v58, s45
    v_perm_b32 v49, v70, v66, s45
    v_mfma_f32_16x16x16_bf16 v[100:103], v[44:45], v[52:53], 0
    v_perm_b32 v52, v62, v58, s46
    v_perm_b32 v53, v70, v66, s46
    v_mfma_f32_16x16x16_bf16 v[104:107], v[44:45], v[48:49], 0
    v_perm_b32 v48, v63, v59, s45
    v_perm_b32 v49, v71, v67, s45
    v_mfma_f32_16x16x16_bf16 v[108:111], v[44:45], v[52:53], 0
    v_perm_b32 v52, v63, v59, s46
    v_perm_b32 v53, v71, v67, s46
    v_mfma_f32_16x16x16_bf16 v[112:115], v[44:45], v[48:49], 0
    s_nop 0
    v_mfma_f32_16x16x16_bf16 v[116:119], v[44:45], v[52:53], 0
    v_mov_b32 v36, v88
    v_mov_b32 v37, v92
    v_mov_b32 v38, v96
    v_mov_b32 v39, v100
    v_mov_b32 v40, v104
    v_mov_b32 v41, v108
    v_mov_b32 v42, v112
    s_nop 0
    v_mov_b32 v43, v116
    ds_write_b128 v18, v[36:39] offset:6144
    ds_write_b128 v18, v[40:43] offset:6160
    s_waitcnt lgkmcnt(0)
    s_mov_b64 exec, 1
    ds_add_u32 v248, v19
    s_mov_b64 exec, -1
    s_lshl_b32 s51, s59, 3
    s_add_u32 s51, s51, s44
    s_lshl_b32 s51, s51, 17
    s_lshl_b32 s50, s52, 8
    s_add_u32 s51, s51, s50
    buffer_load_dwordx4 v[216:219], v16, s[28:31], s51 offen nt
    s_add_u32 s51, s51, 8192
    buffer_load_dwordx4 v[220:223], v16, s[28:31], s51 offen nt
    s_add_u32 s51, s51, 8192
    buffer_load_dwordx4 v[224:227], v16, s[28:31], s51 offen nt
    s_add_u32 s51, s51, 8192
    buffer_load_dwordx4 v[228:231], v16, s[28:31], s51 offen nt
    s_waitcnt vmcnt(4)
    v_perm_b32 v48, v76, v72, s45
    v_perm_b32 v49, v84, v80, s45
    v_perm_b32 v52, v76, v72, s46
    v_perm_b32 v53, v84, v80, s46
    v_mfma_f32_16x16x16_bf16 v[88:91], v[44:45], v[48:49], 0
    v_perm_b32 v48, v77, v73, s45
    v_perm_b32 v49, v85, v81, s45
    v_mfma_f32_16x16x16_bf16 v[92:95], v[44:45], v[52:53], 0
    v_perm_b32 v52, v77, v73, s46
    v_perm_b32 v53, v85, v81, s46
    v_mfma_f32_16x16x16_bf16 v[96:99], v[44:45], v[48:49], 0
    v_perm_b32 v48, v78, v74, s45
    v_perm_b32 v49, v86, v82, s45
    v_mfma_f32_16x16x16_bf16 v[100:103], v[44:45], v[52:53], 0
    v_perm_b32 v52, v78, v74, s46
    v_perm_b32 v53, v86, v82, s46
    v_mfma_f32_16x16x16_bf16 v[104:107], v[44:45], v[48:49], 0
    v_perm_b32 v48, v79, v75, s45
    v_perm_b32 v49, v87, v83, s45
    v_mfma_f32_16x16x16_bf16 v[108:111], v[44:45], v[52:53], 0
    v_perm_b32 v52, v79, v75, s46
    v_perm_b32 v53, v87, v83, s46
    v_mfma_f32_16x16x16_bf16 v[112:115], v[44:45], v[48:49], 0
    s_nop 0
    v_mfma_f32_16x16x16_bf16 v[116:119], v[44:45], v[52:53], 0
    v_mov_b32 v36, v88
    v_mov_b32 v37, v92
    v_mov_b32 v38, v96
    v_mov_b32 v39, v100
    v_mov_b32 v40, v104
    v_mov_b32 v41, v108
    v_mov_b32 v42, v112
    s_nop 0
    v_mov_b32 v43, v116
    ds_write_b128 v18, v[36:39]
    ds_write_b128 v18, v[40:43] offset:16
    s_waitcnt lgkmcnt(0)
    s_mov_b64 exec, 1
    ds_add_u32 v248, v19 offset:12
    s_mov_b64 exec, -1
    s_branch L_A_b1
L_A_w67:
    s_mov_b32 s10, 268435456
    s_mov_b32 s11, 0x20000
    s_mov_b32 s18, 67108864
    s_mov_b32 s19, 0x20000
    s_mov_b32 s30, 4194304
    s_mov_b32 s31, 0x20000
    s_mov_b32 s22, 67108864
    s_mov_b32 s23, 0x20000
    s_mov_b32 s45, 0x05040100
    s_mov_b32 s46, 0x07060302
    s_mov_b32 s47, 0x3e0293ee
    v_lshlrev_b32 v8, 4, v1
    v_mov_b32 v248, 144384
    s_lshl_b32 s38, s59, 2
    s_lshr_b32 s38, 0x665555, s38
    s_and_b32 s38, s38, 15
    s_mov_b32 s49, 131072
    s_mov_b32 s39, 4294836224
    s_cmp_eq_u32 s59, 1
    s_cselect_b32 s49, 458752, s49
    s_cselect_b32 s39, 4294529024, s39
    s_cmp_eq_u32 s59, 2
    s_cselect_b32 s49, 786432, s49
    s_cselect_b32 s39, 4294221824, s39
    s_cmp_eq_u32 s59, 3
    s_cselect_b32 s49, 1114112, s49
    s_cselect_b32 s39, 4293914624, s39
    s_cmp_eq_u32 s59, 4
    s_cselect_b32 s49, 1441792, s49
    s_cselect_b32 s39, 4293607424, s39
    s_cmp_eq_u32 s59, 5
    s_cselect_b32 s49, 1769472, s49
    s_cselect_b32 s39, 4293304320, s39
    s_add_u32 s61, s61, s49
    s_lshl_b32 s49, s44, 13
    s_add_u32 s61, s61, s49
    s_add_u32 s39, s39, s61
    s_lshl_b32 s49, s44, 12
    s_sub_u32 s61, s61, s49
    s_cmp_lt_u32 s59, 4
    s_cselect_b32 s49, 2, 4
    s_cmp_lt_u32 s44, s49
    s_cselect_b32 s63, 6, 5
    s_cmp_eq_u32 s44, 7
    s_cselect_b32 s63, 5, s63
    s_lshl_b32 s50, s44, 2
    s_lshr_b32 s50, 0x1763245, s50
    s_and_b32 s50, s50, 7
    s_cmp_lt_u32 s59, 4
    s_cselect_b32 s49, 4, 8
    s_cmp_lt_u32 s50, s38
    s_cselect_b32 s63, 6, 5
    s_lshl_b32 s50, s50, 12
    s_lshl_b32 s49, s44, 13
    s_sub_u32 s50, s50, s49
    s_add_u32 s39, s39, s50
    s_lshl_b32 s62, s44, 14
    s_mov_b32 s42, 0
    v_lshlrev_b32 v18, 2, v2
    v_xor_b32 v18, v18, v3
    v_lshlrev_b32 v18, 4, v18
    v_lshl_or_b32 v4, v2, 8, v18
    v_xor_b32 v5, 16, v4
    v_xor_b32 v6, 32, v4
    v_xor_b32 v7, 48, v4
    s_waitcnt lgkmcnt(0)
    s_cmp_eq_u32 s44, 7
    s_cbranch_scc1 L_A_svc
    s_barrier
    s_getpc_b64 s[70:71]
L_pc_0:
    s_lshr_b32 s72, s2, 3
    s_and_b32 s72, s72, 7
    s_mul_i32 s72, s72, 4096
    s_sub_u32 s70, s70, L_pc_0-gated_mix__gqa_block_cached__compressed_kv_cla__decode_kernel
    s_subb_u32 s71, s71, 0
    v_lshl_add_u32 v18, v1, 4, s72
    v_min_u32 v60, L_codeend-gated_mix__gqa_block_cached__compressed_kv_cla__decode_kernel-16, v18
    global_load_dwordx4 v[56:59], v60, s[70:71]
    v_add_u32 v18, 1024, v18
    v_min_u32 v60, L_codeend-gated_mix__gqa_block_cached__compressed_kv_cla__decode_kernel-16, v18
    global_load_dwordx4 v[56:59], v60, s[70:71]
    v_add_u32 v18, 1024, v18
    v_min_u32 v60, L_codeend-gated_mix__gqa_block_cached__compressed_kv_cla__decode_kernel-16, v18
    global_load_dwordx4 v[56:59], v60, s[70:71]
    v_add_u32 v18, 1024, v18
    v_min_u32 v60, L_codeend-gated_mix__gqa_block_cached__compressed_kv_cla__decode_kernel-16, v18
    global_load_dwordx4 v[56:59], v60, s[70:71]
    s_lshl_b32 s51, s59, 3
    s_add_u32 s51, s51, s44
    s_lshl_b32 s51, s51, 17
    s_lshl_b32 s50, s52, 8
    s_add_u32 s51, s51, s50
    buffer_load_dwordx4 v[216:219], v16, s[28:31], s51 offen nt
    s_add_u32 s51, s51, 8192
    buffer_load_dwordx4 v[220:223], v16, s[28:31], s51 offen nt
    s_add_u32 s51, s51, 8192
    buffer_load_dwordx4 v[224:227], v16, s[28:31], s51 offen nt
    s_add_u32 s51, s51, 8192
    buffer_load_dwordx4 v[228:231], v16, s[28:31], s51 offen nt
L_A_b1:
    s_add_u32 s49, s61, 0
    s_add_u32 m0, s62, 0
    s_waitcnt vmcnt(2)
    buffer_load_dwordx4 v4, s[16:19], s49 offen offset:0 nt lds
    s_waitcnt vmcnt(2)
    buffer_load_dwordx4 v5, s[16:19], s49 offen offset:1024 nt lds
    s_waitcnt vmcnt(2)
    buffer_load_dwordx4 v6, s[16:19], s49 offen offset:2048 nt lds
    s_waitcnt vmcnt(2)
    buffer_load_dwordx4 v7, s[16:19], s49 offen offset:3072 nt lds
    s_add_u32 s49, s61, 32768
    s_add_u32 m0, s62, 4096
    s_waitcnt vmcnt(2)
    buffer_load_dwordx4 v4, s[16:19], s49 offen offset:0 nt lds
    s_waitcnt vmcnt(2)
    buffer_load_dwordx4 v5, s[16:19], s49 offen offset:1024 nt lds
    s_waitcnt vmcnt(2)
    buffer_load_dwordx4 v6, s[16:19], s49 offen offset:2048 nt lds
    s_waitcnt vmcnt(2)
    buffer_load_dwordx4 v7, s[16:19], s49 offen offset:3072 nt lds
    s_cmp_lg_u32 s42, 0
    s_cbranch_scc1 L_ck_2
    s_call_b64 s[40:41], L_A_chk
L_ck_2:
    s_add_u32 s50, s61, 0
    s_waitcnt vmcnt(2)
    buffer_load_dwordx4 v[120:123], v8, s[20:23], s50 offen offset:0 nt
    s_waitcnt vmcnt(2)
    buffer_load_dwordx4 v[124:127], v8, s[20:23], s50 offen offset:1024 nt
    s_cmp_lg_u32 s42, 0
    s_cbranch_scc1 L_ck_3
    s_call_b64 s[40:41], L_A_chk
L_ck_3:
    s_waitcnt vmcnt(2)
    buffer_load_dwordx4 v[128:131], v8, s[20:23], s50 offen offset:2048 nt
    s_waitcnt vmcnt(2)
    buffer_load_dwordx4 v[132:135], v8, s[20:23], s50 offen offset:3072 nt
    s_cmp_lg_u32 s42, 0
    s_cbranch_scc1 L_ck_4
    s_call_b64 s[40:41], L_A_chk
L_ck_4:
    s_add_u32 s50, s61, 32768
    s_waitcnt vmcnt(2)
    buffer_load_dwordx4 v[136:139], v8, s[20:23], s50 offen offset:0 nt
    s_waitcnt vmcnt(2)
    buffer_load_dwordx4 v[140:143], v8, s[20:23], s50 offen offset:1024 nt
    s_cmp_lg_u32 s42, 0
    s_cbranch_scc1 L_ck_5
    s_call_b64 s[40:41], L_A_chk
L_ck_5:
    s_waitcnt vmcnt(2)
    buffer_load_dwordx4 v[144:147], v8, s[20:23], s50 offen offset:2048 nt
    s_waitcnt vmcnt(2)
    buffer_load_dwordx4 v[148:151], v8, s[20:23], s50 offen offset:3072 nt
    s_cmp_lg_u32 s42, 0
    s_cbranch_scc1 L_ck_6
    s_call_b64 s[40:41], L_A_chk
L_ck_6:
    s_add_u32 s49, s61, 65536
    s_add_u32 m0, s62, 8192
    s_waitcnt vmcnt(2)
    buffer_load_dwordx4 v4, s[16:19], s49 offen offset:0 nt lds
    s_waitcnt vmcnt(2)
    buffer_load_dwordx4 v5, s[16:19], s49 offen offset:1024 nt lds
    s_cmp_lg_u32 s42, 0
    s_cbranch_scc1 L_ck_7
    s_call_b64 s[40:41], L_A_chk
L_ck_7:
    s_waitcnt vmcnt(2)
    buffer_load_dwordx4 v6, s[16:19], s49 offen offset:2048 nt lds
    s_waitcnt vmcnt(2)
    buffer_load_dwordx4 v7, s[16:19], s49 offen offset:3072 nt lds
    s_cmp_lg_u32 s42, 0
    s_cbranch_scc1 L_ck_8
    s_call_b64 s[40:41], L_A_chk
L_ck_8:
    s_add_u32 s49, s61, 98304
    s_add_u32 m0, s62, 12288
    s_waitcnt vmcnt(2)
    buffer_load_dwordx4 v4, s[16:19], s49 offen offset:0 nt lds
    s_waitcnt vmcnt(2)
    buffer_load_dwordx4 v5, s[16:19], s49 offen offset:1024 nt lds
    s_cmp_lg_u32 s42, 0
    s_cbranch_scc1 L_ck_9
    s_call_b64 s[40:41], L_A_chk
L_ck_9:
    s_waitcnt vmcnt(2)
    buffer_load_dwordx4 v6, s[16:19], s49 offen offset:2048 nt lds
    s_waitcnt vmcnt(2)
    buffer_load_dwordx4 v7, s[16:19], s49 offen offset:3072 nt lds
    s_cmp_lg_u32 s42, 0
    s_cbranch_scc1 L_ck_10
    s_call_b64 s[40:41], L_A_chk
L_ck_10:
    s_add_u32 s50, s61, 65536
    s_waitcnt vmcnt(2)
    buffer_load_dwordx4 v[152:155], v8, s[20:23], s50 offen offset:0 nt
    s_waitcnt vmcnt(2)
    buffer_load_dwordx4 v[156:159], v8, s[20:23], s50 offen offset:1024 nt
    s_cmp_lg_u32 s42, 0
    s_cbranch_scc1 L_ck_11
    s_call_b64 s[40:41], L_A_chk
L_ck_11:
    s_waitcnt vmcnt(2)
    buffer_load_dwordx4 v[160:163], v8, s[20:23], s50 offen offset:2048 nt
    s_waitcnt vmcnt(2)
    buffer_load_dwordx4 v[164:167], v8, s[20:23], s50 offen offset:3072 nt
    s_cmp_lg_u32 s42, 0
    s_cbranch_scc1 L_ck_12
    s_call_b64 s[40:41], L_A_chk
L_ck_12:
    s_add_u32 s50, s61, 98304
    s_waitcnt vmcnt(2)
    buffer_load_dwordx4 v[168:171], v8, s[20:23], s50 offen offset:0 nt
    s_waitcnt vmcnt(2)
    buffer_load_dwordx4 v[172:175], v8, s[20:23], s50 offen offset:1024 nt
    s_cmp_lg_u32 s42, 0
    s_cbranch_scc1 L_ck_13
    s_call_b64 s[40:41], L_A_chk
L_ck_13:
    s_waitcnt vmcnt(2)
    buffer_load_dwordx4 v[176:179], v8, s[20:23], s50 offen offset:2048 nt
    s_waitcnt vmcnt(2)
    buffer_load_dwordx4 v[180:183], v8, s[20:23], s50 offen offset:3072 nt
    s_mov_b32 s48, 524288
L_A_wq:
    s_cmp_lg_u32 s42, 0
    s_cbranch_scc1 L_A_wq2
    s_call_b64 s[40:41], L_A_chk
    s_sub_u32 s48, s48, 1
    s_cbranch_scc1 L_end
    s_branch L_A_wq
L_A_wq2:
    ds_read_b32 v18, v248 offset:16
    s_waitcnt lgkmcnt(0)
    v_cmp_eq_u32 vcc, 0, v18
    s_nop 1
    s_cbranch_vccz L_ok_14
    s_sub_u32 s48, s48, 1
    s_cbranch_scc1 L_end
    s_sleep 1
    s_branch L_A_wq2
L_ok_14:
    v_readfirstlane_b32 s42, v18
    s_branch L_A_main
L_A_svc:
    s_setprio 3
    v_mov_b32 v57, 0
    ds_write2_b32 v248, v57, v57 offset0:0 offset1:1
    ds_write2_b32 v248, v57, v57 offset0:2 offset1:3
    ds_write2_b32 v248, v57, v57 offset0:4 offset1:6
    s_waitcnt lgkmcnt(0)
    s_load_dword s64, s[8:9], 0
    s_barrier
    s_mul_i32 s49, s57, 12
    s_add_u32 s65, s49, s60
    s_lshl_b32 s50, s65, 7
    s_add_u32 s50, s50, 12288
    s_getreg_b32 s43, hwreg(HW_REG_XCC_ID, 0, 4)
    s_waitcnt lgkmcnt(0)
    s_mul_i32 s64, s64, 0x9e3779b1
    s_add_u32 s64, s64, 0x7f4a7c15
    v_mov_b32 v58, s64
    v_mov_b32 v59, s43
    s_mov_b64 exec, 1
    buffer_store_dwordx2 v[58:59], v57, s[8:11], s50 offen sc1
    s_mov_b64 exec, -1
    s_mov_b32 s53, 0xff
    v_and_b32 v64, 0xff, v58
    s_lshl_b32 s56, s65, 11
    s_add_u32 s56, s56, 131072
    v_bfe_u32 v9, v1, 4, 1
    v_lshlrev_b32 v9, 15, v9
    v_lshl_add_u32 v9, v3, 4, v9
    v_add_u32 v10, 131072, v8
    s_lshl_b32 s66, s52, 2
    s_add_u32 s66, s66, s59
    s_lshl_b32 s66, s66, 8
    s_add_u32 s66, s66, 524288
    v_min_u32 v18, 15, v1
    s_add_u32 s51, s49, 64
    v_add_u32 v19, s51, v18
    s_lshl_b32 s51, s57, 2
    s_sub_u32 s51, s51, 12
    v_add_u32 v11, s51, v18
    v_cmp_gt_u32 vcc, 12, v18
    s_nop 1
    v_cndmask_b32 v18, v11, v19, vcc
    v_lshlrev_b32 v20, 7, v18
    s_mov_b32 s68, 4096
    s_lshl_b32 s49, s49, 11
    s_add_u32 s49, s49, 131072
    s_mul_i32 s74, s58, 12288
    s_add_u32 s74, s74, s49
    s_lshl_b32 s51, s58, 9
    s_add_u32 s75, s49, s51
    v_lshrrev_b32 v17, 5, v1
    v_mul_u32_u24 v17, 12288, v17
    v_and_b32 v19, 31, v1
    v_lshl_add_u32 v17, v19, 4, v17
    v_lshlrev_b32 v11, 3, v1
    v_add_u32 v11, 143360, v11
    s_mov_b32 s67, 1
    s_lshl_b32 s51, s59, 3
    s_add_u32 s51, s51, s44
    s_lshl_b32 s51, s51, 17
    s_lshl_b32 s50, s52, 8
    s_add_u32 s51, s51, s50
    buffer_load_dwordx4 v[216:219], v16, s[28:31], s51 offen nt
    s_add_u32 s51, s51, 8192
    buffer_load_dwordx4 v[220:223], v16, s[28:31], s51 offen nt
    s_add_u32 s51, s51, 8192
    buffer_load_dwordx4 v[224:227], v16, s[28:31], s51 offen nt
    s_add_u32 s51, s51, 8192
    buffer_load_dwordx4 v[228:231], v16, s[28:31], s51 offen nt
    s_mov_b32 s48, 524288
L_A_wc:
    ds_read_b32 v19, v248 offset:0
    s_waitcnt lgkmcnt(0)
    v_cmp_ne_u32 vcc, 6, v19
    s_nop 1
    s_cbranch_vccz L_ok_15
    s_sub_u32 s48, s48, 1
    s_cbranch_scc1 L_end
    s_branch L_A_wc
L_ok_15:
    ds_read_b128 v[88:91], v10 offset:6144
    ds_read_b128 v[92:95], v10 offset:7168
    ds_read_b128 v[96:99], v10 offset:8192
    ds_read_b128 v[100:103], v10 offset:9216
    ds_read_b128 v[104:107], v10 offset:10240
    ds_read_b128 v[108:111], v10 offset:11264
    s_waitcnt lgkmcnt(0)
    v_add_f32 v88, v88, v92
    v_add_f32 v96, v96, v100
    v_add_f32 v104, v104, v108
    v_add_f32 v89, v89, v93
    v_add_f32 v97, v97, v101
    v_add_f32 v105, v105, v109
    v_add_f32 v90, v90, v94
    v_add_f32 v98, v98, v102
    v_add_f32 v106, v106, v110
    v_add_f32 v91, v91, v95
    v_add_f32 v99, v99, v103
    v_add_f32 v107, v107, v111
    v_add_f32 v88, v88, v96
    v_add_f32 v88, v88, v104
    v_add_f32 v89, v89, v97
    v_add_f32 v89, v89, v105
    v_add_f32 v90, v90, v98
    v_add_f32 v90, v90, v106
    v_add_f32 v91, v91, v99
    v_add_f32 v91, v91, v107
    v_add_u32 v88, 0x80, v88
    v_bfi_b32 v184, s53, v58, v88
    v_add_u32 v89, 0x80, v89
    v_bfi_b32 v185, s53, v58, v89
    v_add_u32 v90, 0x80, v90
    v_bfi_b32 v186, s53, v58, v90
    v_add_u32 v91, 0x80, v91
    v_bfi_b32 v187, s53, v58, v91
    buffer_store_dwordx4 v[184:187], v8, s[8:11], s56 offen offset:1024
L_A_bq:
    buffer_load_dwordx2 v[36:37], v20, s[8:11], s68 offen sc1
    s_mov_b32 s50, s74
    buffer_load_dwordx4 v[120:123], v8, s[8:11], s50 offen offset:1024 sc1
    buffer_load_dwordx4 v[124:127], v8, s[8:11], s50 offen offset:3072 sc1
    s_add_u32 s50, s50, 4096
    buffer_load_dwordx4 v[128:131], v8, s[8:11], s50 offen offset:1024 sc1
    buffer_load_dwordx4 v[132:135], v8, s[8:11], s50 offen offset:3072 sc1
    s_add_u32 s50, s50, 4096
    buffer_load_dwordx4 v[136:139], v8, s[8:11], s50 offen offset:1024 sc1
    buffer_load_dwordx4 v[140:143], v8, s[8:11], s50 offen offset:3072 sc1
    s_waitcnt vmcnt(0)
    s_cmp_lg_u32 s67, 1
    s_cbranch_scc1 L_fs_16
    v_cmp_ne_u32 s[54:55], v36, v58
    s_nop 1
    s_cmp_lg_u64 s[54:55], 0
    s_cbranch_scc1 L_fs_16
    v_cmp_ne_u32 s[54:55], v37, v59
    s_nop 1
    s_cmp_eq_u64 s[54:55], 0
    s_cselect_b32 s67, 2, 0
    s_cmp_lg_u32 s67, 0
    s_cbranch_scc1 L_fs_16
    buffer_store_dwordx4 v[184:187], v8, s[8:11], s56 offen offset:1024 sc1
L_fs_16:
    v_xor_b32 v120, v64, v120
    v_xor_b32 v121, v64, v121
    v_xor_b32 v122, v64, v122
    v_xor_b32 v123, v64, v123
    v_xor_b32 v124, v64, v124
    v_xor_b32 v125, v64, v125
    v_xor_b32 v126, v64, v126
    v_xor_b32 v127, v64, v127
    v_xor_b32 v128, v64, v128
    v_xor_b32 v129, v64, v129
    v_xor_b32 v130, v64, v130
    v_xor_b32 v131, v64, v131
    v_xor_b32 v132, v64, v132
    v_xor_b32 v133, v64, v133
    v_xor_b32 v134, v64, v134
    v_xor_b32 v135, v64, v135
    v_xor_b32 v136, v64, v136
    v_xor_b32 v137, v64, v137
    v_xor_b32 v138, v64, v138
    v_xor_b32 v139, v64, v139
    v_xor_b32 v140, v64, v140
    v_xor_b32 v141, v64, v141
    v_xor_b32 v142, v64, v142
    v_xor_b32 v143, v64, v143
    v_or3_b32 v19, v120, v121, v122
    v_or3_b32 v48, v123, v124, v125
    v_or3_b32 v19, v19, v126, v127
    v_or3_b32 v48, v48, v128, v129
    v_or3_b32 v19, v19, v130, v131
    v_or3_b32 v48, v48, v132, v133
    v_or3_b32 v19, v19, v134, v135
    v_or3_b32 v48, v48, v136, v137
    v_or3_b32 v19, v19, v138, v139
    v_or3_b32 v48, v48, v140, v141
    v_or3_b32 v19, v19, v142, v143
    v_or_b32 v19, v19, v48
    v_and_b32 v19, 0xff, v19
    v_cmp_ne_u32 vcc, 0, v19
    s_nop 1
    s_cbranch_vccz L_ok_17
    s_sub_u32 s48, s48, 1
    s_cbranch_scc1 L_end
    s_branch L_A_bq
L_ok_17:
    v_add_f32 v120, v120, v124
    v_add_f32 v128, v128, v132
    v_add_f32 v136, v136, v140
    v_add_f32 v121, v121, v125
    v_add_f32 v129, v129, v133
    v_add_f32 v137, v137, v141
    v_add_f32 v122, v122, v126
    v_add_f32 v130, v130, v134
    v_add_f32 v138, v138, v142
    v_add_f32 v123, v123, v127
    v_add_f32 v131, v131, v135
    v_add_f32 v139, v139, v143
    v_add_f32 v120, v120, v128
    v_add_f32 v120, v120, v136
    v_add_f32 v121, v121, v129
    v_add_f32 v121, v121, v137
    v_add_f32 v122, v122, v130
    v_add_f32 v122, v122, v138
    v_add_f32 v123, v123, v131
    v_add_f32 v123, v123, v139
    v_cvt_pk_bf16_f32 v120, v120, v121
    v_cvt_pk_bf16_f32 v121, v122, v123
    ds_write_b64 v11, v[120:121] offset:512
    v_mov_b32 v18, 1
    s_waitcnt lgkmcnt(0)
    ds_write_b32 v248, v18 offset:4
    s_call_b64 s[40:41], L_A_qfn
L_A_wc2:
    ds_read_b32 v19, v248 offset:12
    s_waitcnt lgkmcnt(0)
    v_cmp_ne_u32 vcc, 6, v19
    s_nop 1
    s_cbranch_vccz L_ok_18
    s_sub_u32 s48, s48, 1
    s_cbranch_scc1 L_end
    s_branch L_A_wc2
L_ok_18:
    ds_read_b128 v[88:91], v10 offset:0
    ds_read_b128 v[92:95], v10 offset:1024
    ds_read_b128 v[96:99], v10 offset:2048
    ds_read_b128 v[100:103], v10 offset:3072
    ds_read_b128 v[104:107], v10 offset:4096
    ds_read_b128 v[108:111], v10 offset:5120
    s_waitcnt lgkmcnt(0)
    v_add_f32 v88, v88, v92
    v_add_f32 v96, v96, v100
    v_add_f32 v104, v104, v108
    v_add_f32 v89, v89, v93
    v_add_f32 v97, v97, v101
    v_add_f32 v105, v105, v109
    v_add_f32 v90, v90, v94
    v_add_f32 v98, v98, v102
    v_add_f32 v106, v106, v110
    v_add_f32 v91, v91, v95
    v_add_f32 v99, v99, v103
    v_add_f32 v107, v107, v111
    v_add_f32 v88, v88, v96
    v_add_f32 v88, v88, v104
    v_add_f32 v89, v89, v97
    v_add_f32 v89, v89, v105
    v_add_f32 v90, v90, v98
    v_add_f32 v90, v90, v106
    v_add_f32 v91, v91, v99
    v_add_f32 v91, v91, v107
    v_add_u32 v88, 0x80, v88
    v_bfi_b32 v188, s53, v58, v88
    v_add_u32 v89, 0x80, v89
    v_bfi_b32 v189, s53, v58, v89
    v_add_u32 v90, 0x80, v90
    v_bfi_b32 v190, s53, v58, v90
    v_add_u32 v91, 0x80, v91
    v_bfi_b32 v191, s53, v58, v91
    s_cmp_lg_u32 s67, 1
    s_cbranch_scc1 L_A_lk
L_A_vf:
    buffer_load_dwordx2 v[36:37], v20, s[8:11], s68 offen sc1
    s_waitcnt vmcnt(0)
    s_cmp_lg_u32 s67, 1
    s_cbranch_scc1 L_fs_19
    v_cmp_ne_u32 s[54:55], v36, v58
    s_nop 1
    s_cmp_lg_u64 s[54:55], 0
    s_cbranch_scc1 L_fs_19
    v_cmp_ne_u32 s[54:55], v37, v59
    s_nop 1
    s_cmp_eq_u64 s[54:55], 0
    s_cselect_b32 s67, 2, 0
    s_cmp_lg_u32 s67, 0
    s_cbranch_scc1 L_fs_19
    buffer_store_dwordx4 v[184:187], v8, s[8:11], s56 offen offset:1024 sc1
L_fs_19:
    s_cmp_eq_u32 s67, 1
    s_cbranch_scc0 L_ok_20
    s_sub_u32 s48, s48, 1
    s_cbranch_scc1 L_end
    s_branch L_A_vf
L_ok_20:
L_A_lk:
    s_cmp_lg_u32 s67, 0
    s_cbranch_scc1 L_fl_21
    buffer_store_dwordx4 v[188:191], v8, s[8:11], s56 offen offset:0 sc1
    s_branch L_fl_21d
L_fl_21:
    buffer_store_dwordx4 v[188:191], v8, s[8:11], s56 offen offset:0
L_fl_21d:
    s_add_u32 s49, s61, 0
    s_add_u32 m0, s62, 0
    s_nop 0
    buffer_load_dwordx4 v4, s[16:19], s49 offen offset:0 nt lds
    buffer_load_dwordx4 v5, s[16:19], s49 offen offset:1024 nt lds
    buffer_load_dwordx4 v6, s[16:19], s49 offen offset:2048 nt lds
    buffer_load_dwordx4 v7, s[16:19], s49 offen offset:3072 nt lds
    s_add_u32 s49, s61, 32768
    s_add_u32 m0, s62, 4096
    s_nop 0
    buffer_load_dwordx4 v4, s[16:19], s49 offen offset:0 nt lds
    buffer_load_dwordx4 v5, s[16:19], s49 offen offset:1024 nt lds
    buffer_load_dwordx4 v6, s[16:19], s49 offen offset:2048 nt lds
    buffer_load_dwordx4 v7, s[16:19], s49 offen offset:3072 nt lds
    s_cmp_ge_u32 s59, 4
    s_cbranch_scc1 L_A_nq2
L_A_ws:
    ds_read_b32 v19, v248 offset:8
    s_waitcnt lgkmcnt(0)
    v_cmp_ne_u32 vcc, 8, v19
    s_nop 1
    s_cbranch_vccz L_ok_22
    s_sub_u32 s48, s48, 1
    s_cbranch_scc1 L_end
    s_branch L_A_ws
L_ok_22:
    v_add_u32 v18, 144896, v8
    s_mov_b32 exec_hi, 0
    ds_read_b128 v[184:187], v18
    s_waitcnt lgkmcnt(0)
    v_min_u32 v184, -2, v184
    v_min_u32 v185, -2, v185
    v_min_u32 v186, -2, v186
    v_min_u32 v187, -2, v187
    buffer_store_dwordx4 v[184:187], v9, s[8:11], s66 offen sc1
    s_mov_b64 exec, -1
L_A_nq2:
L_A_aq:
    s_mov_b32 s50, s75
    buffer_load_dwordx4 v[120:123], v17, s[8:11], s50 offen offset:0 sc1
    buffer_load_dwordx4 v[124:127], v17, s[8:11], s50 offen offset:2048 sc1
    s_add_u32 s50, s50, 4096
    buffer_load_dwordx4 v[128:131], v17, s[8:11], s50 offen offset:0 sc1
    buffer_load_dwordx4 v[132:135], v17, s[8:11], s50 offen offset:2048 sc1
    s_add_u32 s50, s50, 4096
    buffer_load_dwordx4 v[136:139], v17, s[8:11], s50 offen offset:0 sc1
    buffer_load_dwordx4 v[140:143], v17, s[8:11], s50 offen offset:2048 sc1
    s_waitcnt vmcnt(0)
    v_xor_b32 v120, v64, v120
    v_xor_b32 v121, v64, v121
    v_xor_b32 v122, v64, v122
    v_xor_b32 v123, v64, v123
    v_xor_b32 v124, v64, v124
    v_xor_b32 v125, v64, v125
    v_xor_b32 v126, v64, v126
    v_xor_b32 v127, v64, v127
    v_xor_b32 v128, v64, v128
    v_xor_b32 v129, v64, v129
    v_xor_b32 v130, v64, v130
    v_xor_b32 v131, v64, v131
    v_xor_b32 v132, v64, v132
    v_xor_b32 v133, v64, v133
    v_xor_b32 v134, v64, v134
    v_xor_b32 v135, v64, v135
    v_xor_b32 v136, v64, v136
    v_xor_b32 v137, v64, v137
    v_xor_b32 v138, v64, v138
    v_xor_b32 v139, v64, v139
    v_xor_b32 v140, v64, v140
    v_xor_b32 v141, v64, v141
    v_xor_b32 v142, v64, v142
    v_xor_b32 v143, v64, v143
    v_or3_b32 v19, v120, v121, v122
    v_or3_b32 v48, v123, v124, v125
    v_or3_b32 v19, v19, v126, v127
    v_or3_b32 v48, v48, v128, v129
    v_or3_b32 v19, v19, v130, v131
    v_or3_b32 v48, v48, v132, v133
    v_or3_b32 v19, v19, v134, v135
    v_or3_b32 v48, v48, v136, v137
    v_or3_b32 v19, v19, v138, v139
    v_or3_b32 v48, v48, v140, v141
    v_or3_b32 v19, v19, v142, v143
    v_or_b32 v19, v19, v48
    v_and_b32 v19, 0xff, v19
    v_cmp_ne_u32 vcc, 0, v19
    s_nop 1
    s_cbranch_vccz L_ok_23
    s_sub_u32 s48, s48, 1
    s_cbranch_scc1 L_end
    s_branch L_A_aq
L_ok_23:
    v_add_f32 v120, v120, v124
    v_add_f32 v128, v128, v132
    v_add_f32 v136, v136, v140
    v_add_f32 v121, v121, v125
    v_add_f32 v129, v129, v133
    v_add_f32 v137, v137, v141
    v_add_f32 v122, v122, v126
    v_add_f32 v130, v130, v134
    v_add_f32 v138, v138, v142
    v_add_f32 v123, v123, v127
    v_add_f32 v131, v131, v135
    v_add_f32 v139, v139, v143
    v_add_f32 v120, v120, v128
    v_add_f32 v120, v120, v136
    v_add_f32 v121, v121, v129
    v_add_f32 v121, v121, v137
    v_add_f32 v122, v122, v130
    v_add_f32 v122, v122, v138
    v_add_f32 v123, v123, v131
    v_add_f32 v123, v123, v139
    v_cvt_pk_bf16_f32 v120, v120, v121
    v_cvt_pk_bf16_f32 v121, v122, v123
    ds_write_b64 v11, v[120:121] offset:0
    ds_write_b32 v248, v58 offset:20
    s_or_b32 s42, s67, 1
    v_mov_b32 v18, s42
    s_waitcnt lgkmcnt(0)
    ds_write_b32 v248, v18 offset:16
    s_setprio 0
    s_add_u32 s50, s61, 0
    s_waitcnt vmcnt(4)
    buffer_load_dwordx4 v[120:123], v8, s[20:23], s50 offen offset:0 nt
    s_waitcnt vmcnt(4)
    buffer_load_dwordx4 v[124:127], v8, s[20:23], s50 offen offset:1024 nt
    s_waitcnt vmcnt(4)
    buffer_load_dwordx4 v[128:131], v8, s[20:23], s50 offen offset:2048 nt
    s_waitcnt vmcnt(4)
    buffer_load_dwordx4 v[132:135], v8, s[20:23], s50 offen offset:3072 nt
    s_add_u32 s50, s61, 32768
    s_waitcnt vmcnt(4)
    buffer_load_dwordx4 v[136:139], v8, s[20:23], s50 offen offset:0 nt
    s_waitcnt vmcnt(4)
    buffer_load_dwordx4 v[140:143], v8, s[20:23], s50 offen offset:1024 nt
    s_waitcnt vmcnt(4)
    buffer_load_dwordx4 v[144:147], v8, s[20:23], s50 offen offset:2048 nt
    s_waitcnt vmcnt(4)
    buffer_load_dwordx4 v[148:151], v8, s[20:23], s50 offen offset:3072 nt
    s_add_u32 s49, s61, 65536
    s_add_u32 m0, s62, 8192
    s_waitcnt vmcnt(4)
    buffer_load_dwordx4 v4, s[16:19], s49 offen offset:0 nt lds
    s_waitcnt vmcnt(4)
    buffer_load_dwordx4 v5, s[16:19], s49 offen offset:1024 nt lds
    s_waitcnt vmcnt(4)
    buffer_load_dwordx4 v6, s[16:19], s49 offen offset:2048 nt lds
    s_waitcnt vmcnt(4)
    buffer_load_dwordx4 v7, s[16:19], s49 offen offset:3072 nt lds
    s_add_u32 s49, s61, 98304
    s_add_u32 m0, s62, 12288
    s_waitcnt vmcnt(4)
    buffer_load_dwordx4 v4, s[16:19], s49 offen offset:0 nt lds
    s_waitcnt vmcnt(4)
    buffer_load_dwordx4 v5, s[16:19], s49 offen offset:1024 nt lds
    s_waitcnt vmcnt(4)
    buffer_load_dwordx4 v6, s[16:19], s49 offen offset:2048 nt lds
    s_waitcnt vmcnt(4)
    buffer_load_dwordx4 v7, s[16:19], s49 offen offset:3072 nt lds
    s_add_u32 s50, s61, 65536
    s_waitcnt vmcnt(4)
    buffer_load_dwordx4 v[152:155], v8, s[20:23], s50 offen offset:0 nt
    s_waitcnt vmcnt(4)
    buffer_load_dwordx4 v[156:159], v8, s[20:23], s50 offen offset:1024 nt
    s_waitcnt vmcnt(4)
    buffer_load_dwordx4 v[160:163], v8, s[20:23], s50 offen offset:2048 nt
    s_waitcnt vmcnt(4)
    buffer_load_dwordx4 v[164:167], v8, s[20:23], s50 offen offset:3072 nt
    s_add_u32 s50, s61, 98304
    s_waitcnt vmcnt(4)
    buffer_load_dwordx4 v[168:171], v8, s[20:23], s50 offen offset:0 nt
    s_waitcnt vmcnt(4)
    buffer_load_dwordx4 v[172:175], v8, s[20:23], s50 offen offset:1024 nt
    s_waitcnt vmcnt(4)
    buffer_load_dwordx4 v[176:179], v8, s[20:23], s50 offen offset:2048 nt
    s_waitcnt vmcnt(4)
    buffer_load_dwordx4 v[180:183], v8, s[20:23], s50 offen offset:3072 nt
    s_branch L_A_main
L_A_chk:
    ds_read_b32 v18, v248 offset:4
    s_waitcnt lgkmcnt(0)
    v_readfirstlane_b32 s42, v18
    s_nop 1
    s_cmp_lg_u32 s42, 0
    s_cbranch_scc1 L_A_qfn
    s_setpc_b64 s[40:41]
L_A_qfn:
    s_cmp_ge_u32 s59, 4
    s_cbranch_scc1 L_A_nqa
    v_lshlrev_b32 v18, 4, v3
    v_add_u32 v18, 143872, v18
    ds_read_b128 v[232:235], v18
    ds_read_b128 v[236:239], v18 offset:256
    v_and_b32 v19, 1, v1
    v_cmp_eq_u32 vcc, 0, v19
    v_lshlrev_b32 v19, 8, v19
    v_lshl_add_u32 v19, v2, 3, v19
    s_lshl_b32 s51, s44, 5
    s_add_u32 s51, s51, 144896
    v_add_u32 v19, s51, v19
    v_mov_b32 v18, 1
    s_waitcnt vmcnt(8) lgkmcnt(0)
    v_dot2_f32_bf16 v240, v216, v232, 0
    v_dot2_f32_bf16 v241, v220, v232, 0
    v_dot2_f32_bf16 v242, v224, v232, 0
    v_dot2_f32_bf16 v243, v228, v232, 0
    v_dot2_f32_bf16 v244, v216, v236, 0
    v_dot2_f32_bf16 v245, v220, v236, 0
    v_dot2_f32_bf16 v246, v224, v236, 0
    v_dot2_f32_bf16 v247, v228, v236, 0
    v_dot2_f32_bf16 v240, v217, v233, v240
    v_dot2_f32_bf16 v241, v221, v233, v241
    v_dot2_f32_bf16 v242, v225, v233, v242
    v_dot2_f32_bf16 v243, v229, v233, v243
    v_dot2_f32_bf16 v244, v217, v237, v244
    v_dot2_f32_bf16 v245, v221, v237, v245
    v_dot2_f32_bf16 v246, v225, v237, v246
    v_dot2_f32_bf16 v247, v229, v237, v247
    v_dot2_f32_bf16 v240, v218, v234, v240
    v_dot2_f32_bf16 v241, v222, v234, v241
    v_dot2_f32_bf16 v242, v226, v234, v242
    v_dot2_f32_bf16 v243, v230, v234, v243
    v_dot2_f32_bf16 v244, v218, v238, v244
    v_dot2_f32_bf16 v245, v222, v238, v245
    v_dot2_f32_bf16 v246, v226, v238, v246
    v_dot2_f32_bf16 v247, v230, v238, v247
    v_dot2_f32_bf16 v240, v219, v235, v240
    v_dot2_f32_bf16 v241, v223, v235, v241
    v_dot2_f32_bf16 v242, v227, v235, v242
    v_dot2_f32_bf16 v243, v231, v235, v243
    v_dot2_f32_bf16 v244, v219, v239, v244
    v_dot2_f32_bf16 v245, v223, v239, v245
    v_dot2_f32_bf16 v246, v227, v239, v246
    v_dot2_f32_bf16 v247, v231, v239, v247
    v_add_f32_dpp v240, v240, v240 row_ror:8 row_mask:0xf bank_mask:0xf
    v_add_f32_dpp v241, v241, v241 row_ror:8 row_mask:0xf bank_mask:0xf
    v_add_f32_dpp v242, v242, v242 row_ror:8 row_mask:0xf bank_mask:0xf
    v_add_f32_dpp v243, v243, v243 row_ror:8 row_mask:0xf bank_mask:0xf
    v_add_f32_dpp v244, v244, v244 row_ror:8 row_mask:0xf bank_mask:0xf
    v_add_f32_dpp v245, v245, v245 row_ror:8 row_mask:0xf bank_mask:0xf
    v_add_f32_dpp v246, v246, v246 row_ror:8 row_mask:0xf bank_mask:0xf
    v_add_f32_dpp v247, v247, v247 row_ror:8 row_mask:0xf bank_mask:0xf
    v_add_f32_dpp v240, v240, v240 row_ror:4 row_mask:0xf bank_mask:0xf
    v_add_f32_dpp v241, v241, v241 row_ror:4 row_mask:0xf bank_mask:0xf
    v_add_f32_dpp v242, v242, v242 row_ror:4 row_mask:0xf bank_mask:0xf
    v_add_f32_dpp v243, v243, v243 row_ror:4 row_mask:0xf bank_mask:0xf
    v_add_f32_dpp v244, v244, v244 row_ror:4 row_mask:0xf bank_mask:0xf
    v_add_f32_dpp v245, v245, v245 row_ror:4 row_mask:0xf bank_mask:0xf
    v_add_f32_dpp v246, v246, v246 row_ror:4 row_mask:0xf bank_mask:0xf
    v_add_f32_dpp v247, v247, v247 row_ror:4 row_mask:0xf bank_mask:0xf
    v_add_f32_dpp v240, v240, v240 row_ror:2 row_mask:0xf bank_mask:0xf
    v_add_f32_dpp v241, v241, v241 row_ror:2 row_mask:0xf bank_mask:0xf
    v_add_f32_dpp v242, v242, v242 row_ror:2 row_mask:0xf bank_mask:0xf
    v_add_f32_dpp v243, v243, v243 row_ror:2 row_mask:0xf bank_mask:0xf
    v_add_f32_dpp v244, v244, v244 row_ror:2 row_mask:0xf bank_mask:0xf
    v_add_f32_dpp v245, v245, v245 row_ror:2 row_mask:0xf bank_mask:0xf
    v_add_f32_dpp v246, v246, v246 row_ror:2 row_mask:0xf bank_mask:0xf
    v_add_f32_dpp v247, v247, v247 row_ror:2 row_mask:0xf bank_mask:0xf
    v_add_f32_dpp v240, v240, v240 row_ror:1 row_mask:0xf bank_mask:0xf
    v_add_f32_dpp v241, v241, v241 row_ror:1 row_mask:0xf bank_mask:0xf
    v_add_f32_dpp v242, v242, v242 row_ror:1 row_mask:0xf bank_mask:0xf
    v_add_f32_dpp v243, v243, v243 row_ror:1 row_mask:0xf bank_mask:0xf
    v_add_f32_dpp v244, v244, v244 row_ror:1 row_mask:0xf bank_mask:0xf
    v_add_f32_dpp v245, v245, v245 row_ror:1 row_mask:0xf bank_mask:0xf
    v_add_f32_dpp v246, v246, v246 row_ror:1 row_mask:0xf bank_mask:0xf
    v_add_f32_dpp v247, v247, v247 row_ror:1 row_mask:0xf bank_mask:0xf
    v_cvt_pk_bf16_f32 v232, v240, v241
    v_cvt_pk_bf16_f32 v233, v242, v243
    v_cvt_pk_bf16_f32 v234, v244, v245
    v_cvt_pk_bf16_f32 v235, v246, v247
    v_cndmask_b32 v232, v234, v232, vcc
    v_cndmask_b32 v233, v235, v233, vcc
    ds_write_b64 v19, v[232:233]
    s_waitcnt lgkmcnt(0)
    s_mov_b64 exec, 1
    ds_add_u32 v248, v18 offset:8
    s_mov_b64 exec, -1
L_A_nqa:
    s_setpc_b64 s[40:41]
    .p2align 6
L_A_main:
    v_xor_b32 v18, v2, v3
    v_lshlrev_b32 v18, 4, v18
    v_and_b32 v19, 3, v3
    v_lshl_or_b32 v18, v19, 10, v18
    v_lshrrev_b32 v19, 2, v3
    v_lshl_or_b32 v18, v19, 8, v18
    v_add_u32 v12, s62, v18
    v_xor_b32 v13, 64, v12
    v_xor_b32 v14, 0x80, v12
    v_xor_b32 v15, 0xc0, v12
    v_and_b32 v19, 1, v19
    v_lshlrev_b32 v19, 8, v19
    v_lshl_add_u32 v19, v2, 4, v19
    v_add_u32 v19, 143360, v19
    ds_read_b128 v[20:23], v19 offset:0
    ds_read_b128 v[24:27], v19 offset:64
    ds_read_b128 v[28:31], v19 offset:128
    ds_read_b128 v[32:35], v19 offset:192
    v_bfe_u32 v184, v1, 4, 1
    v_lshlrev_b32 v184, 9, v184
    v_lshl_add_u32 v184, v3, 5, v184
    s_lshl_b32 s51, s44, 10
    s_add_u32 s51, s51, 147456
    v_add_u32 v184, s51, v184
    v_bfe_u32 v185, v1, 2, 1
    v_lshlrev_b32 v185, 5, v185
    s_lshl_b32 s51, s44, 2
    s_add_u32 s51, s51, 157696
    v_add_u32 v185, s51, v185
    s_lshl_b32 s51, s44, 8
    s_add_u32 s51, s51, 147456
    v_lshl_add_u32 v186, v1, 2, s51
    s_lshr_b32 s51, s44, 1
    s_lshl_b32 s51, s51, 5
    s_add_u32 s51, s51, 157696
    v_and_b32 v187, 7, v1
    v_lshl_add_u32 v187, v187, 2, s51
    v_lshrrev_b32 v188, 2, v1
    v_lshlrev_b32 v188, 8, v188
    v_and_b32 v189, 3, v1
    v_lshl_add_u32 v188, v189, 2, v188
    s_lshr_b32 s53, s52, 1
    s_lshl_b32 s53, s53, 2
    s_add_u32 s53, s53, s44
    s_lshl_b32 s54, s53, 7
    s_lshl_b32 s53, s53, 12
    s_lshl_b32 s51, s59, 1
    s_add_u32 s51, s51, s58
    s_lshl_b32 s55, s51, 3
    s_add_u32 s54, s54, s55
    s_add_u32 s54, s54, 98304
    s_lshl_b32 s51, s51, 4
    s_add_u32 s53, s53, s51
    s_add_u32 s53, s53, 655360
    ds_read_b32 v191, v248 offset:20
    s_and_b32 s42, s42, 2
    s_mov_b32 s55, 0xff
    v_and_b32 v184, 31, v1
    s_mul_i32 s51, s44, 1152
    s_add_u32 s51, s51, 147456
    v_lshl_add_u32 v184, v184, 2, s51
    v_and_b32 v186, 7, v1
    v_mul_u32_u24 v186, 36, v186
    v_lshrrev_b32 v189, 3, v1
    v_add_u32 v186, v186, v189
    s_lshl_b32 s51, s44, 5
    s_add_u32 s51, s51, 147456
    v_lshl_add_u32 v186, v186, 2, s51
    s_mov_b32 s47, 0x3fb8aa3b
    s_waitcnt vmcnt(23)
    ds_read_b128 v[56:59], v12 offset:0
    ds_read_b128 v[60:63], v13 offset:0
    ds_read_b128 v[64:67], v14 offset:0
    ds_read_b128 v[68:71], v15 offset:0
    ds_read_b128 v[72:75], v12 offset:4096
    ds_read_b128 v[76:79], v13 offset:4096
    ds_read_b128 v[80:83], v14 offset:4096
    ds_read_b128 v[84:87], v15 offset:4096
    s_waitcnt lgkmcnt(0)
    v_mfma_f32_16x16x32_bf16 v[36:39], v[56:59], v[20:23], 0
    v_mfma_f32_16x16x32_bf16 v[40:43], v[72:75], v[20:23], 0
    v_mfma_f32_16x16x32_bf16 v[36:39], v[60:63], v[24:27], v[36:39]
    v_mfma_f32_16x16x32_bf16 v[40:43], v[76:79], v[24:27], v[40:43]
    v_mfma_f32_16x16x32_bf16 v[36:39], v[64:67], v[28:31], v[36:39]
    v_mfma_f32_16x16x32_bf16 v[40:43], v[80:83], v[28:31], v[40:43]
    v_mfma_f32_16x16x32_bf16 v[36:39], v[68:71], v[32:35], v[36:39]
    v_mfma_f32_16x16x32_bf16 v[40:43], v[84:87], v[32:35], v[40:43]
    s_add_u32 s49, s61, 131072
    s_add_u32 m0, s62, 0
    s_waitcnt vmcnt(2)
    buffer_load_dwordx4 v4, s[16:19], s49 offen offset:0 nt lds
    s_waitcnt vmcnt(2)
    buffer_load_dwordx4 v5, s[16:19], s49 offen offset:1024 nt lds
    s_waitcnt vmcnt(2)
    buffer_load_dwordx4 v6, s[16:19], s49 offen offset:2048 nt lds
    s_waitcnt vmcnt(2)
    buffer_load_dwordx4 v7, s[16:19], s49 offen offset:3072 nt lds
    s_add_u32 s49, s61, 163840
    s_add_u32 m0, s62, 4096
    s_waitcnt vmcnt(2)
    buffer_load_dwordx4 v4, s[16:19], s49 offen offset:0 nt lds
    v_cvt_pk_bf16_f32 v44, v36, v37
    v_cvt_pk_bf16_f32 v45, v38, v39
    v_cvt_pk_bf16_f32 v46, v40, v41
    v_cvt_pk_bf16_f32 v47, v42, v43
    v_lshlrev_b32 v36, 16, v44
    v_and_b32 v37, 0xffff0000, v44
    v_lshlrev_b32 v38, 16, v45
    v_and_b32 v39, 0xffff0000, v45
    v_lshlrev_b32 v40, 16, v46
    v_and_b32 v41, 0xffff0000, v46
    v_lshlrev_b32 v42, 16, v47
    v_and_b32 v43, 0xffff0000, v47
    v_mul_f32 v36, 0x3db504f3, v36
    v_mul_f32 v37, 0x3db504f3, v37
    v_mul_f32 v38, 0x3db504f3, v38
    v_mul_f32 v39, 0x3db504f3, v39
    v_mul_f32 v40, 0x3db504f3, v40
    v_mul_f32 v41, 0x3db504f3, v41
    v_mul_f32 v42, 0x3db504f3, v42
    v_mul_f32 v43, 0x3db504f3, v43
    v_cvt_pk_bf16_f32 v44, v36, v37
    v_cvt_pk_bf16_f32 v45, v38, v39
    v_cvt_pk_bf16_f32 v46, v40, v41
    v_cvt_pk_bf16_f32 v47, v42, v43
    v_lshlrev_b32 v36, 16, v44
    v_and_b32 v37, 0xffff0000, v44
    v_lshlrev_b32 v38, 16, v45
    v_and_b32 v39, 0xffff0000, v45
    v_lshlrev_b32 v40, 16, v46
    v_and_b32 v41, 0xffff0000, v46
    v_lshlrev_b32 v42, 16, v47
    v_and_b32 v43, 0xffff0000, v47
    v_max3_f32 v18, v36, v37, v38
    v_max3_f32 v18, v18, v39, v40
    v_max3_f32 v18, v18, v41, v42
    v_max_f32 v18, v18, v43
    v_mov_b32 v19, v18
    s_nop 1
    v_permlane32_swap_b32 v19, v18
    v_max_f32 v18, v19, v18
    v_mov_b32 v19, v18
    s_nop 1
    v_permlane16_swap_b32 v19, v18
    v_max_f32 v18, v19, v18
    s_add_u32 s49, s61, 163840
    s_add_u32 m0, s62, 4096
    s_waitcnt vmcnt(2)
    buffer_load_dwordx4 v5, s[16:19], s49 offen offset:1024 nt lds
    v_mul_f32 v16, s47, v18
    v_mov_b32 v9, v18
    v_fma_f32 v36, v36, s47, -v16
    v_fma_f32 v37, v37, s47, -v16
    v_fma_f32 v38, v38, s47, -v16
    v_fma_f32 v39, v39, s47, -v16
    v_fma_f32 v40, v40, s47, -v16
    v_fma_f32 v41, v41, s47, -v16
    v_fma_f32 v42, v42, s47, -v16
    v_fma_f32 v43, v43, s47, -v16
    v_exp_f32 v36, v36
    v_exp_f32 v37, v37
    v_exp_f32 v38, v38
    v_exp_f32 v39, v39
    v_exp_f32 v40, v40
    v_exp_f32 v41, v41
    v_exp_f32 v42, v42
    v_exp_f32 v43, v43
    v_cvt_pk_bf16_f32 v44, v36, v37
    v_cvt_pk_bf16_f32 v45, v38, v39
    v_cvt_pk_bf16_f32 v46, v40, v41
    v_cvt_pk_bf16_f32 v47, v42, v43
    v_add_f32 v36, v36, v37
    v_add_f32 v38, v38, v39
    v_add_f32 v40, v40, v41
    v_add_f32 v42, v42, v43
    v_add_f32 v36, v36, v38
    v_add_f32 v40, v40, v42
    v_add_f32 v36, v36, v40
    v_mov_b32 v10, v36
    s_add_u32 s49, s61, 163840
    s_add_u32 m0, s62, 4096
    s_waitcnt vmcnt(2)
    buffer_load_dwordx4 v6, s[16:19], s49 offen offset:2048 nt lds
    s_waitcnt vmcnt(23)
    v_perm_b32 v48, v124, v120, s45
    v_perm_b32 v49, v132, v128, s45
    v_perm_b32 v50, v140, v136, s45
    v_perm_b32 v51, v148, v144, s45
    v_perm_b32 v52, v124, v120, s46
    v_perm_b32 v53, v132, v128, s46
    v_perm_b32 v54, v140, v136, s46
    v_perm_b32 v55, v148, v144, s46
    v_mfma_f32_16x16x32_bf16 v[88:91], v[44:47], v[48:51], 0
    v_perm_b32 v48, v125, v121, s45
    v_perm_b32 v49, v133, v129, s45
    v_perm_b32 v50, v141, v137, s45
    v_perm_b32 v51, v149, v145, s45
    v_mfma_f32_16x16x32_bf16 v[92:95], v[44:47], v[52:55], 0
    v_perm_b32 v52, v125, v121, s46
    v_perm_b32 v53, v133, v129, s46
    v_perm_b32 v54, v141, v137, s46
    v_perm_b32 v55, v149, v145, s46
    v_mfma_f32_16x16x32_bf16 v[96:99], v[44:47], v[48:51], 0
    s_add_u32 s49, s61, 163840
    s_add_u32 m0, s62, 4096
    s_waitcnt vmcnt(2)
    buffer_load_dwordx4 v7, s[16:19], s49 offen offset:3072 nt lds
    v_perm_b32 v48, v126, v122, s45
    v_perm_b32 v49, v134, v130, s45
    v_perm_b32 v50, v142, v138, s45
    v_perm_b32 v51, v150, v146, s45
    v_mfma_f32_16x16x32_bf16 v[100:103], v[44:47], v[52:55], 0
    v_perm_b32 v52, v126, v122, s46
    v_perm_b32 v53, v134, v130, s46
    v_perm_b32 v54, v142, v138, s46
    v_perm_b32 v55, v150, v146, s46
    v_mfma_f32_16x16x32_bf16 v[104:107], v[44:47], v[48:51], 0
    v_perm_b32 v48, v127, v123, s45
    v_perm_b32 v49, v135, v131, s45
    v_perm_b32 v50, v143, v139, s45
    v_perm_b32 v51, v151, v147, s45
    v_mfma_f32_16x16x32_bf16 v[108:111], v[44:47], v[52:55], 0
    v_perm_b32 v52, v127, v123, s46
    v_perm_b32 v53, v135, v131, s46
    v_perm_b32 v54, v143, v139, s46
    v_perm_b32 v55, v151, v147, s46
    v_mfma_f32_16x16x32_bf16 v[112:115], v[44:47], v[48:51], 0
    s_nop 0
    v_mfma_f32_16x16x32_bf16 v[116:119], v[44:47], v[52:55], 0
    s_add_u32 s50, s61, 131072
    s_waitcnt vmcnt(2)
    buffer_load_dwordx4 v[120:123], v8, s[20:23], s50 offen offset:0 nt
    s_waitcnt vmcnt(2)
    buffer_load_dwordx4 v[124:127], v8, s[20:23], s50 offen offset:1024 nt
    s_waitcnt vmcnt(2)
    buffer_load_dwordx4 v[128:131], v8, s[20:23], s50 offen offset:2048 nt
    s_waitcnt vmcnt(2)
    buffer_load_dwordx4 v[132:135], v8, s[20:23], s50 offen offset:3072 nt
    s_add_u32 s50, s61, 163840
    s_waitcnt vmcnt(2)
    buffer_load_dwordx4 v[136:139], v8, s[20:23], s50 offen offset:0 nt
    s_waitcnt vmcnt(2)
    buffer_load_dwordx4 v[140:143], v8, s[20:23], s50 offen offset:1024 nt
    s_waitcnt vmcnt(2)
    buffer_load_dwordx4 v[144:147], v8, s[20:23], s50 offen offset:2048 nt
    s_waitcnt vmcnt(23)
    ds_read_b128 v[56:59], v12 offset:8192
    ds_read_b128 v[60:63], v13 offset:8192
    ds_read_b128 v[64:67], v14 offset:8192
    ds_read_b128 v[68:71], v15 offset:8192
    ds_read_b128 v[72:75], v12 offset:12288
    ds_read_b128 v[76:79], v13 offset:12288
    ds_read_b128 v[80:83], v14 offset:12288
    ds_read_b128 v[84:87], v15 offset:12288
    s_add_u32 s50, s61, 163840
    s_waitcnt vmcnt(2)
    buffer_load_dwordx4 v[148:151], v8, s[20:23], s50 offen offset:3072 nt
    s_waitcnt lgkmcnt(0)
    v_mfma_f32_16x16x32_bf16 v[36:39], v[56:59], v[20:23], 0
    v_mfma_f32_16x16x32_bf16 v[40:43], v[72:75], v[20:23], 0
    v_mfma_f32_16x16x32_bf16 v[36:39], v[60:63], v[24:27], v[36:39]
    v_mfma_f32_16x16x32_bf16 v[40:43], v[76:79], v[24:27], v[40:43]
    v_mfma_f32_16x16x32_bf16 v[36:39], v[64:67], v[28:31], v[36:39]
    v_mfma_f32_16x16x32_bf16 v[40:43], v[80:83], v[28:31], v[40:43]
    v_mfma_f32_16x16x32_bf16 v[36:39], v[68:71], v[32:35], v[36:39]
    v_mfma_f32_16x16x32_bf16 v[40:43], v[84:87], v[32:35], v[40:43]
    s_add_u32 s49, s61, 196608
    s_add_u32 m0, s62, 8192
    s_waitcnt vmcnt(3)
    buffer_load_dwordx4 v4, s[16:19], s49 offen offset:0 nt lds
    s_waitcnt vmcnt(3)
    buffer_load_dwordx4 v5, s[16:19], s49 offen offset:1024 nt lds
    s_waitcnt vmcnt(3)
    buffer_load_dwordx4 v6, s[16:19], s49 offen offset:2048 nt lds
    s_waitcnt vmcnt(3)
    buffer_load_dwordx4 v7, s[16:19], s49 offen offset:3072 nt lds
    s_add_u32 s49, s61, 229376
    s_add_u32 m0, s62, 12288
    s_waitcnt vmcnt(3)
    buffer_load_dwordx4 v4, s[16:19], s49 offen offset:0 nt lds
    v_cvt_pk_bf16_f32 v44, v36, v37
    v_cvt_pk_bf16_f32 v45, v38, v39
    v_cvt_pk_bf16_f32 v46, v40, v41
    v_cvt_pk_bf16_f32 v47, v42, v43
    v_lshlrev_b32 v36, 16, v44
    v_and_b32 v37, 0xffff0000, v44
    v_lshlrev_b32 v38, 16, v45
    v_and_b32 v39, 0xffff0000, v45
    v_lshlrev_b32 v40, 16, v46
    v_and_b32 v41, 0xffff0000, v46
    v_lshlrev_b32 v42, 16, v47
    v_and_b32 v43, 0xffff0000, v47
    v_mul_f32 v36, 0x3db504f3, v36
    v_mul_f32 v37, 0x3db504f3, v37
    v_mul_f32 v38, 0x3db504f3, v38
    v_mul_f32 v39, 0x3db504f3, v39
    v_mul_f32 v40, 0x3db504f3, v40
    v_mul_f32 v41, 0x3db504f3, v41
    v_mul_f32 v42, 0x3db504f3, v42
    v_mul_f32 v43, 0x3db504f3, v43
    v_cvt_pk_bf16_f32 v44, v36, v37
    v_cvt_pk_bf16_f32 v45, v38, v39
    v_cvt_pk_bf16_f32 v46, v40, v41
    v_cvt_pk_bf16_f32 v47, v42, v43
    v_lshlrev_b32 v36, 16, v44
    v_and_b32 v37, 0xffff0000, v44
    v_lshlrev_b32 v38, 16, v45
    v_and_b32 v39, 0xffff0000, v45
    v_lshlrev_b32 v40, 16, v46
    v_and_b32 v41, 0xffff0000, v46
    v_lshlrev_b32 v42, 16, v47
    v_and_b32 v43, 0xffff0000, v47
    v_max3_f32 v18, v36, v37, v38
    v_max3_f32 v18, v18, v39, v40
    v_max3_f32 v18, v18, v41, v42
    v_max3_f32 v18, v18, v43, v9
    v_mov_b32 v19, v18
    s_nop 1
    v_permlane32_swap_b32 v19, v18
    v_max_f32 v18, v19, v18
    v_mov_b32 v19, v18
    s_nop 1
    v_permlane16_swap_b32 v19, v18
    v_max_f32 v18, v19, v18
    s_add_u32 s49, s61, 229376
    s_add_u32 m0, s62, 12288
    s_waitcnt vmcnt(3)
    buffer_load_dwordx4 v5, s[16:19], s49 offen offset:1024 nt lds
    v_mul_f32 v16, s47, v18
    v_fma_f32 v11, v9, s47, -v16
    v_exp_f32 v11, v11
    v_mov_b32 v9, v18
    v_fma_f32 v36, v36, s47, -v16
    v_fma_f32 v37, v37, s47, -v16
    v_fma_f32 v38, v38, s47, -v16
    v_fma_f32 v39, v39, s47, -v16
    v_fma_f32 v40, v40, s47, -v16
    v_fma_f32 v41, v41, s47, -v16
    v_fma_f32 v42, v42, s47, -v16
    v_fma_f32 v43, v43, s47, -v16
    v_mov_b32_dpp v17, v11 row_newbcast:0 row_mask:0x5 bank_mask:0xf
    s_nop 1
    v_mov_b32_dpp v17, v11 row_newbcast:4 row_mask:0xa bank_mask:0xf
    v_exp_f32 v36, v36
    v_exp_f32 v37, v37
    v_exp_f32 v38, v38
    v_exp_f32 v39, v39
    v_exp_f32 v40, v40
    v_exp_f32 v41, v41
    v_exp_f32 v42, v42
    v_exp_f32 v43, v43
    v_mul_f32 v88, v17, v88
    v_mul_f32 v92, v17, v92
    v_mul_f32 v96, v17, v96
    v_mul_f32 v100, v17, v100
    v_mul_f32 v104, v17, v104
    v_mul_f32 v108, v17, v108
    v_mul_f32 v112, v17, v112
    v_mul_f32 v116, v17, v116
    v_cvt_pk_bf16_f32 v44, v36, v37
    v_cvt_pk_bf16_f32 v45, v38, v39
    v_cvt_pk_bf16_f32 v46, v40, v41
    v_cvt_pk_bf16_f32 v47, v42, v43
    v_add_f32 v36, v36, v37
    v_add_f32 v38, v38, v39
    v_add_f32 v40, v40, v41
    v_add_f32 v42, v42, v43
    v_add_f32 v36, v36, v38
    v_add_f32 v40, v40, v42
    v_add_f32 v36, v36, v40
    v_fma_f32 v10, v10, v11, v36
    s_add_u32 s49, s61, 229376
    s_add_u32 m0, s62, 12288
    s_waitcnt vmcnt(3)
    buffer_load_dwordx4 v6, s[16:19], s49 offen offset:2048 nt lds
    s_waitcnt vmcnt(23)
    v_perm_b32 v48, v156, v152, s45
    v_perm_b32 v49, v164, v160, s45
    v_perm_b32 v50, v172, v168, s45
    v_perm_b32 v51, v180, v176, s45
    v_perm_b32 v52, v156, v152, s46
    v_perm_b32 v53, v164, v160, s46
    v_perm_b32 v54, v172, v168, s46
    v_perm_b32 v55, v180, v176, s46
    v_mfma_f32_16x16x32_bf16 v[88:91], v[44:47], v[48:51], v[88:91]
    v_perm_b32 v48, v157, v153, s45
    v_perm_b32 v49, v165, v161, s45
    v_perm_b32 v50, v173, v169, s45
    v_perm_b32 v51, v181, v177, s45
    v_mfma_f32_16x16x32_bf16 v[92:95], v[44:47], v[52:55], v[92:95]
    v_perm_b32 v52, v157, v153, s46
    v_perm_b32 v53, v165, v161, s46
    v_perm_b32 v54, v173, v169, s46
    v_perm_b32 v55, v181, v177, s46
    v_mfma_f32_16x16x32_bf16 v[96:99], v[44:47], v[48:51], v[96:99]
    s_add_u32 s49, s61, 229376
    s_add_u32 m0, s62, 12288
    s_waitcnt vmcnt(3)
    buffer_load_dwordx4 v7, s[16:19], s49 offen offset:3072 nt lds
    v_perm_b32 v48, v158, v154, s45
    v_perm_b32 v49, v166, v162, s45
    v_perm_b32 v50, v174, v170, s45
    v_perm_b32 v51, v182, v178, s45
    v_mfma_f32_16x16x32_bf16 v[100:103], v[44:47], v[52:55], v[100:103]
    v_perm_b32 v52, v158, v154, s46
    v_perm_b32 v53, v166, v162, s46
    v_perm_b32 v54, v174, v170, s46
    v_perm_b32 v55, v182, v178, s46
    v_mfma_f32_16x16x32_bf16 v[104:107], v[44:47], v[48:51], v[104:107]
    v_perm_b32 v48, v159, v155, s45
    v_perm_b32 v49, v167, v163, s45
    v_perm_b32 v50, v175, v171, s45
    v_perm_b32 v51, v183, v179, s45
    v_mfma_f32_16x16x32_bf16 v[108:111], v[44:47], v[52:55], v[108:111]
    v_perm_b32 v52, v159, v155, s46
    v_perm_b32 v53, v167, v163, s46
    v_perm_b32 v54, v175, v171, s46
    v_perm_b32 v55, v183, v179, s46
    v_mfma_f32_16x16x32_bf16 v[112:115], v[44:47], v[48:51], v[112:115]
    s_nop 0
    v_mfma_f32_16x16x32_bf16 v[116:119], v[44:47], v[52:55], v[116:119]
    s_add_u32 s50, s61, 196608
    s_waitcnt vmcnt(3)
    buffer_load_dwordx4 v[152:155], v8, s[20:23], s50 offen offset:0 nt
    s_waitcnt vmcnt(3)
    buffer_load_dwordx4 v[156:159], v8, s[20:23], s50 offen offset:1024 nt
    s_waitcnt vmcnt(3)
    buffer_load_dwordx4 v[160:163], v8, s[20:23], s50 offen offset:2048 nt
    s_waitcnt vmcnt(3)
    buffer_load_dwordx4 v[164:167], v8, s[20:23], s50 offen offset:3072 nt
    s_add_u32 s50, s61, 229376
    s_waitcnt vmcnt(3)
    buffer_load_dwordx4 v[168:171], v8, s[20:23], s50 offen offset:0 nt
    s_waitcnt vmcnt(3)
    buffer_load_dwordx4 v[172:175], v8, s[20:23], s50 offen offset:1024 nt
    s_waitcnt vmcnt(3)
    buffer_load_dwordx4 v[176:179], v8, s[20:23], s50 offen offset:2048 nt
    s_waitcnt vmcnt(23)
    ds_read_b128 v[56:59], v12 offset:0
    ds_read_b128 v[60:63], v13 offset:0
    ds_read_b128 v[64:67], v14 offset:0
    ds_read_b128 v[68:71], v15 offset:0
    ds_read_b128 v[72:75], v12 offset:4096
    ds_read_b128 v[76:79], v13 offset:4096
    ds_read_b128 v[80:83], v14 offset:4096
    ds_read_b128 v[84:87], v15 offset:4096
    s_add_u32 s50, s61, 229376
    s_waitcnt vmcnt(3)
    buffer_load_dwordx4 v[180:183], v8, s[20:23], s50 offen offset:3072 nt
    s_waitcnt lgkmcnt(0)
    v_mfma_f32_16x16x32_bf16 v[36:39], v[56:59], v[20:23], 0
    v_mfma_f32_16x16x32_bf16 v[40:43], v[72:75], v[20:23], 0
    v_mfma_f32_16x16x32_bf16 v[36:39], v[60:63], v[24:27], v[36:39]
    v_mfma_f32_16x16x32_bf16 v[40:43], v[76:79], v[24:27], v[40:43]
    v_mfma_f32_16x16x32_bf16 v[36:39], v[64:67], v[28:31], v[36:39]
    v_mfma_f32_16x16x32_bf16 v[40:43], v[80:83], v[28:31], v[40:43]
    v_mfma_f32_16x16x32_bf16 v[36:39], v[68:71], v[32:35], v[36:39]
    v_mfma_f32_16x16x32_bf16 v[40:43], v[84:87], v[32:35], v[40:43]
    s_add_u32 s49, s61, 262144
    s_add_u32 m0, s62, 0
    s_waitcnt vmcnt(4)
    buffer_load_dwordx4 v4, s[16:19], s49 offen offset:0 nt lds
    s_waitcnt vmcnt(4)
    buffer_load_dwordx4 v5, s[16:19], s49 offen offset:1024 nt lds
    s_waitcnt vmcnt(4)
    buffer_load_dwordx4 v6, s[16:19], s49 offen offset:2048 nt lds
    s_waitcnt vmcnt(4)
    buffer_load_dwordx4 v7, s[16:19], s49 offen offset:3072 nt lds
    s_add_u32 s49, s61, 294912
    s_add_u32 m0, s62, 4096
    s_waitcnt vmcnt(4)
    buffer_load_dwordx4 v4, s[16:19], s49 offen offset:0 nt lds
    v_cvt_pk_bf16_f32 v44, v36, v37
    v_cvt_pk_bf16_f32 v45, v38, v39
    v_cvt_pk_bf16_f32 v46, v40, v41
    v_cvt_pk_bf16_f32 v47, v42, v43
    v_lshlrev_b32 v36, 16, v44
    v_and_b32 v37, 0xffff0000, v44
    v_lshlrev_b32 v38, 16, v45
    v_and_b32 v39, 0xffff0000, v45
    v_lshlrev_b32 v40, 16, v46
    v_and_b32 v41, 0xffff0000, v46
    v_lshlrev_b32 v42, 16, v47
    v_and_b32 v43, 0xffff0000, v47
    v_mul_f32 v36, 0x3db504f3, v36
    v_mul_f32 v37, 0x3db504f3, v37
    v_mul_f32 v38, 0x3db504f3, v38
    v_mul_f32 v39, 0x3db504f3, v39
    v_mul_f32 v40, 0x3db504f3, v40
    v_mul_f32 v41, 0x3db504f3, v41
    v_mul_f32 v42, 0x3db504f3, v42
    v_mul_f32 v43, 0x3db504f3, v43
    v_cvt_pk_bf16_f32 v44, v36, v37
    v_cvt_pk_bf16_f32 v45, v38, v39
    v_cvt_pk_bf16_f32 v46, v40, v41
    v_cvt_pk_bf16_f32 v47, v42, v43
    v_lshlrev_b32 v36, 16, v44
    v_and_b32 v37, 0xffff0000, v44
    v_lshlrev_b32 v38, 16, v45
    v_and_b32 v39, 0xffff0000, v45
    v_lshlrev_b32 v40, 16, v46
    v_and_b32 v41, 0xffff0000, v46
    v_lshlrev_b32 v42, 16, v47
    v_and_b32 v43, 0xffff0000, v47
    v_max3_f32 v18, v36, v37, v38
    v_max3_f32 v18, v18, v39, v40
    v_max3_f32 v18, v18, v41, v42
    v_max3_f32 v18, v18, v43, v9
    v_mov_b32 v19, v18
    s_nop 1
    v_permlane32_swap_b32 v19, v18
    v_max_f32 v18, v19, v18
    v_mov_b32 v19, v18
    s_nop 1
    v_permlane16_swap_b32 v19, v18
    v_max_f32 v18, v19, v18
    s_add_u32 s49, s61, 294912
    s_add_u32 m0, s62, 4096
    s_waitcnt vmcnt(4)
    buffer_load_dwordx4 v5, s[16:19], s49 offen offset:1024 nt lds
    v_mul_f32 v16, s47, v18
    v_fma_f32 v11, v9, s47, -v16
    v_exp_f32 v11, v11
    v_mov_b32 v9, v18
    v_fma_f32 v36, v36, s47, -v16
    v_fma_f32 v37, v37, s47, -v16
    v_fma_f32 v38, v38, s47, -v16
    v_fma_f32 v39, v39, s47, -v16
    v_fma_f32 v40, v40, s47, -v16
    v_fma_f32 v41, v41, s47, -v16
    v_fma_f32 v42, v42, s47, -v16
    v_fma_f32 v43, v43, s47, -v16
    v_mov_b32_dpp v17, v11 row_newbcast:0 row_mask:0x5 bank_mask:0xf
    s_nop 1
    v_mov_b32_dpp v17, v11 row_newbcast:4 row_mask:0xa bank_mask:0xf
    v_exp_f32 v36, v36
    v_exp_f32 v37, v37
    v_exp_f32 v38, v38
    v_exp_f32 v39, v39
    v_exp_f32 v40, v40
    v_exp_f32 v41, v41
    v_exp_f32 v42, v42
    v_exp_f32 v43, v43
    v_mul_f32 v88, v17, v88
    v_mul_f32 v92, v17, v92
    v_mul_f32 v96, v17, v96
    v_mul_f32 v100, v17, v100
    v_mul_f32 v104, v17, v104
    v_mul_f32 v108, v17, v108
    v_mul_f32 v112, v17, v112
    v_mul_f32 v116, v17, v116
    v_cvt_pk_bf16_f32 v44, v36, v37
    v_cvt_pk_bf16_f32 v45, v38, v39
    v_cvt_pk_bf16_f32 v46, v40, v41
    v_cvt_pk_bf16_f32 v47, v42, v43
    v_add_f32 v36, v36, v37
    v_add_f32 v38, v38, v39
    v_add_f32 v40, v40, v41
    v_add_f32 v42, v42, v43
    v_add_f32 v36, v36, v38
    v_add_f32 v40, v40, v42
    v_add_f32 v36, v36, v40
    v_fma_f32 v10, v10, v11, v36
    s_add_u32 s49, s61, 294912
    s_add_u32 m0, s62, 4096
    s_waitcnt vmcnt(4)
    buffer_load_dwordx4 v6, s[16:19], s49 offen offset:2048 nt lds
    s_waitcnt vmcnt(23)
    v_perm_b32 v48, v124, v120, s45
    v_perm_b32 v49, v132, v128, s45
    v_perm_b32 v50, v140, v136, s45
    v_perm_b32 v51, v148, v144, s45
    v_perm_b32 v52, v124, v120, s46
    v_perm_b32 v53, v132, v128, s46
    v_perm_b32 v54, v140, v136, s46
    v_perm_b32 v55, v148, v144, s46
    v_mfma_f32_16x16x32_bf16 v[88:91], v[44:47], v[48:51], v[88:91]
    v_perm_b32 v48, v125, v121, s45
    v_perm_b32 v49, v133, v129, s45
    v_perm_b32 v50, v141, v137, s45
    v_perm_b32 v51, v149, v145, s45
    v_mfma_f32_16x16x32_bf16 v[92:95], v[44:47], v[52:55], v[92:95]
    v_perm_b32 v52, v125, v121, s46
    v_perm_b32 v53, v133, v129, s46
    v_perm_b32 v54, v141, v137, s46
    v_perm_b32 v55, v149, v145, s46
    v_mfma_f32_16x16x32_bf16 v[96:99], v[44:47], v[48:51], v[96:99]
    s_add_u32 s49, s61, 294912
    s_add_u32 m0, s62, 4096
    s_waitcnt vmcnt(4)
    buffer_load_dwordx4 v7, s[16:19], s49 offen offset:3072 nt lds
    v_perm_b32 v48, v126, v122, s45
    v_perm_b32 v49, v134, v130, s45
    v_perm_b32 v50, v142, v138, s45
    v_perm_b32 v51, v150, v146, s45
    v_mfma_f32_16x16x32_bf16 v[100:103], v[44:47], v[52:55], v[100:103]
    v_perm_b32 v52, v126, v122, s46
    v_perm_b32 v53, v134, v130, s46
    v_perm_b32 v54, v142, v138, s46
    v_perm_b32 v55, v150, v146, s46
    v_mfma_f32_16x16x32_bf16 v[104:107], v[44:47], v[48:51], v[104:107]
    v_perm_b32 v48, v127, v123, s45
    v_perm_b32 v49, v135, v131, s45
    v_perm_b32 v50, v143, v139, s45
    v_perm_b32 v51, v151, v147, s45
    v_mfma_f32_16x16x32_bf16 v[108:111], v[44:47], v[52:55], v[108:111]
    v_perm_b32 v52, v127, v123, s46
    v_perm_b32 v53, v135, v131, s46
    v_perm_b32 v54, v143, v139, s46
    v_perm_b32 v55, v151, v147, s46
    v_mfma_f32_16x16x32_bf16 v[112:115], v[44:47], v[48:51], v[112:115]
    s_nop 0
    v_mfma_f32_16x16x32_bf16 v[116:119], v[44:47], v[52:55], v[116:119]
    s_add_u32 s50, s61, 262144
    s_waitcnt vmcnt(4)
    buffer_load_dwordx4 v[120:123], v8, s[20:23], s50 offen offset:0 nt
    s_waitcnt vmcnt(4)
    buffer_load_dwordx4 v[124:127], v8, s[20:23], s50 offen offset:1024 nt
    s_waitcnt vmcnt(4)
    buffer_load_dwordx4 v[128:131], v8, s[20:23], s50 offen offset:2048 nt
    s_waitcnt vmcnt(4)
    buffer_load_dwordx4 v[132:135], v8, s[20:23], s50 offen offset:3072 nt
    s_add_u32 s50, s61, 294912
    s_waitcnt vmcnt(4)
    buffer_load_dwordx4 v[136:139], v8, s[20:23], s50 offen offset:0 nt
    s_waitcnt vmcnt(4)
    buffer_load_dwordx4 v[140:143], v8, s[20:23], s50 offen offset:1024 nt
    s_waitcnt vmcnt(4)
    buffer_load_dwordx4 v[144:147], v8, s[20:23], s50 offen offset:2048 nt
    s_waitcnt vmcnt(23)
    ds_read_b128 v[56:59], v12 offset:8192
    ds_read_b128 v[60:63], v13 offset:8192
    ds_read_b128 v[64:67], v14 offset:8192
    ds_read_b128 v[68:71], v15 offset:8192
    ds_read_b128 v[72:75], v12 offset:12288
    ds_read_b128 v[76:79], v13 offset:12288
    ds_read_b128 v[80:83], v14 offset:12288
    ds_read_b128 v[84:87], v15 offset:12288
    s_add_u32 s50, s61, 294912
    s_waitcnt vmcnt(4)
    buffer_load_dwordx4 v[148:151], v8, s[20:23], s50 offen offset:3072 nt
    s_waitcnt lgkmcnt(0)
    v_mfma_f32_16x16x32_bf16 v[36:39], v[56:59], v[20:23], 0
    v_mfma_f32_16x16x32_bf16 v[40:43], v[72:75], v[20:23], 0
    v_mfma_f32_16x16x32_bf16 v[36:39], v[60:63], v[24:27], v[36:39]
    v_mfma_f32_16x16x32_bf16 v[40:43], v[76:79], v[24:27], v[40:43]
    v_mfma_f32_16x16x32_bf16 v[36:39], v[64:67], v[28:31], v[36:39]
    v_mfma_f32_16x16x32_bf16 v[40:43], v[80:83], v[28:31], v[40:43]
    v_mfma_f32_16x16x32_bf16 v[36:39], v[68:71], v[32:35], v[36:39]
    v_mfma_f32_16x16x32_bf16 v[40:43], v[84:87], v[32:35], v[40:43]
    s_cmp_le_u32 s63, 5
    s_cbranch_scc1 L_ci_24
    s_add_u32 s49, s39, 0
    s_add_u32 m0, s62, 8192
    s_nop 0
    buffer_load_dwordx4 v4, s[16:19], s49 offen offset:0 nt lds
    buffer_load_dwordx4 v5, s[16:19], s49 offen offset:1024 nt lds
    buffer_load_dwordx4 v6, s[16:19], s49 offen offset:2048 nt lds
    buffer_load_dwordx4 v7, s[16:19], s49 offen offset:3072 nt lds
L_ci_24:
    s_nop 4
    v_cvt_pk_bf16_f32 v44, v36, v37
    v_cvt_pk_bf16_f32 v45, v38, v39
    v_cvt_pk_bf16_f32 v46, v40, v41
    v_cvt_pk_bf16_f32 v47, v42, v43
    v_lshlrev_b32 v36, 16, v44
    v_and_b32 v37, 0xffff0000, v44
    v_lshlrev_b32 v38, 16, v45
    v_and_b32 v39, 0xffff0000, v45
    v_lshlrev_b32 v40, 16, v46
    v_and_b32 v41, 0xffff0000, v46
    v_lshlrev_b32 v42, 16, v47
    v_and_b32 v43, 0xffff0000, v47
    v_mul_f32 v36, 0x3db504f3, v36
    v_mul_f32 v37, 0x3db504f3, v37
    v_mul_f32 v38, 0x3db504f3, v38
    v_mul_f32 v39, 0x3db504f3, v39
    v_mul_f32 v40, 0x3db504f3, v40
    v_mul_f32 v41, 0x3db504f3, v41
    v_mul_f32 v42, 0x3db504f3, v42
    v_mul_f32 v43, 0x3db504f3, v43
    v_cvt_pk_bf16_f32 v44, v36, v37
    v_cvt_pk_bf16_f32 v45, v38, v39
    v_cvt_pk_bf16_f32 v46, v40, v41
    v_cvt_pk_bf16_f32 v47, v42, v43
    v_lshlrev_b32 v36, 16, v44
    v_and_b32 v37, 0xffff0000, v44
    v_lshlrev_b32 v38, 16, v45
    v_and_b32 v39, 0xffff0000, v45
    v_lshlrev_b32 v40, 16, v46
    v_and_b32 v41, 0xffff0000, v46
    v_lshlrev_b32 v42, 16, v47
    v_and_b32 v43, 0xffff0000, v47
    v_max3_f32 v18, v36, v37, v38
    v_max3_f32 v18, v18, v39, v40
    v_max3_f32 v18, v18, v41, v42
    v_max3_f32 v18, v18, v43, v9
    v_mov_b32 v19, v18
    s_nop 1
    v_permlane32_swap_b32 v19, v18
    v_max_f32 v18, v19, v18
    v_mov_b32 v19, v18
    s_nop 1
    v_permlane16_swap_b32 v19, v18
    v_max_f32 v18, v19, v18
    v_mul_f32 v16, s47, v18
    v_fma_f32 v11, v9, s47, -v16
    v_exp_f32 v11, v11
    v_mov_b32 v9, v18
    v_fma_f32 v36, v36, s47, -v16
    v_fma_f32 v37, v37, s47, -v16
    v_fma_f32 v38, v38, s47, -v16
    v_fma_f32 v39, v39, s47, -v16
    v_fma_f32 v40, v40, s47, -v16
    v_fma_f32 v41, v41, s47, -v16
    v_fma_f32 v42, v42, s47, -v16
    v_fma_f32 v43, v43, s47, -v16
    v_mov_b32_dpp v17, v11 row_newbcast:0 row_mask:0x5 bank_mask:0xf
    s_nop 1
    v_mov_b32_dpp v17, v11 row_newbcast:4 row_mask:0xa bank_mask:0xf
    v_exp_f32 v36, v36
    v_exp_f32 v37, v37
    v_exp_f32 v38, v38
    v_exp_f32 v39, v39
    v_exp_f32 v40, v40
    v_exp_f32 v41, v41
    v_exp_f32 v42, v42
    v_exp_f32 v43, v43
    v_mul_f32 v88, v17, v88
    v_mul_f32 v92, v17, v92
    v_mul_f32 v96, v17, v96
    v_mul_f32 v100, v17, v100
    v_mul_f32 v104, v17, v104
    v_mul_f32 v108, v17, v108
    v_mul_f32 v112, v17, v112
    v_mul_f32 v116, v17, v116
    v_cvt_pk_bf16_f32 v44, v36, v37
    v_cvt_pk_bf16_f32 v45, v38, v39
    v_cvt_pk_bf16_f32 v46, v40, v41
    v_cvt_pk_bf16_f32 v47, v42, v43
    v_add_f32 v36, v36, v37
    v_add_f32 v38, v38, v39
    v_add_f32 v40, v40, v41
    v_add_f32 v42, v42, v43
    v_add_f32 v36, v36, v38
    v_add_f32 v40, v40, v42
    v_add_f32 v36, v36, v40
    v_fma_f32 v10, v10, v11, v36
    s_waitcnt vmcnt(16)
    v_perm_b32 v48, v156, v152, s45
    v_perm_b32 v49, v164, v160, s45
    v_perm_b32 v50, v172, v168, s45
    v_perm_b32 v51, v180, v176, s45
    v_perm_b32 v52, v156, v152, s46
    v_perm_b32 v53, v164, v160, s46
    v_perm_b32 v54, v172, v168, s46
    v_perm_b32 v55, v180, v176, s46
    v_mfma_f32_16x16x32_bf16 v[88:91], v[44:47], v[48:51], v[88:91]
    v_perm_b32 v48, v157, v153, s45
    v_perm_b32 v49, v165, v161, s45
    v_perm_b32 v50, v173, v169, s45
    v_perm_b32 v51, v181, v177, s45
    v_mfma_f32_16x16x32_bf16 v[92:95], v[44:47], v[52:55], v[92:95]
    v_perm_b32 v52, v157, v153, s46
    v_perm_b32 v53, v165, v161, s46
    v_perm_b32 v54, v173, v169, s46
    v_perm_b32 v55, v181, v177, s46
    v_mfma_f32_16x16x32_bf16 v[96:99], v[44:47], v[48:51], v[96:99]
    v_perm_b32 v48, v158, v154, s45
    v_perm_b32 v49, v166, v162, s45
    v_perm_b32 v50, v174, v170, s45
    v_perm_b32 v51, v182, v178, s45
    v_mfma_f32_16x16x32_bf16 v[100:103], v[44:47], v[52:55], v[100:103]
    v_perm_b32 v52, v158, v154, s46
    v_perm_b32 v53, v166, v162, s46
    v_perm_b32 v54, v174, v170, s46
    v_perm_b32 v55, v182, v178, s46
    v_mfma_f32_16x16x32_bf16 v[104:107], v[44:47], v[48:51], v[104:107]
    v_perm_b32 v48, v159, v155, s45
    v_perm_b32 v49, v167, v163, s45
    v_perm_b32 v50, v175, v171, s45
    v_perm_b32 v51, v183, v179, s45
    v_mfma_f32_16x16x32_bf16 v[108:111], v[44:47], v[52:55], v[108:111]
    v_perm_b32 v52, v159, v155, s46
    v_perm_b32 v53, v167, v163, s46
    v_perm_b32 v54, v175, v171, s46
    v_perm_b32 v55, v183, v179, s46
    v_mfma_f32_16x16x32_bf16 v[112:115], v[44:47], v[48:51], v[112:115]
    s_nop 0
    v_mfma_f32_16x16x32_bf16 v[116:119], v[44:47], v[52:55], v[116:119]
    s_cmp_le_u32 s63, 5
    s_cbranch_scc1 L_ci_25
    s_add_u32 s50, s39, 0
    buffer_load_dwordx4 v[152:155], v8, s[20:23], s50 offen offset:0 nt
    buffer_load_dwordx4 v[156:159], v8, s[20:23], s50 offen offset:1024 nt
    buffer_load_dwordx4 v[160:163], v8, s[20:23], s50 offen offset:2048 nt
    buffer_load_dwordx4 v[164:167], v8, s[20:23], s50 offen offset:3072 nt
L_ci_25:
    s_cmp_lg_u32 s44, 4
    s_cbranch_scc1 L_ms_26
    s_lshl_b32 s51, s57, 5
    s_add_u32 s51, s51, s60
    s_lshl_b32 s51, s51, 2
    s_add_u32 s51, s51, 65536
    s_mov_b64 exec, 1
    s_cmp_lg_u32 s42, 0
    s_cbranch_scc1 L_fl_27
    buffer_store_dword v191, v188, s[8:11], s51 offen sc1
    s_branch L_fl_27d
L_fl_27:
    buffer_store_dword v191, v188, s[8:11], s51 offen
L_fl_27d:
    s_mov_b64 exec, -1
L_ms_26:
    s_waitcnt vmcnt(16)
    s_cmp_lg_u32 s63, 5
    s_cbranch_scc1 L_cw_28
    s_waitcnt vmcnt(8)
L_cw_28:
    ds_read_b128 v[56:59], v12 offset:0
    ds_read_b128 v[60:63], v13 offset:0
    ds_read_b128 v[64:67], v14 offset:0
    ds_read_b128 v[68:71], v15 offset:0
    ds_read_b128 v[72:75], v12 offset:4096
    ds_read_b128 v[76:79], v13 offset:4096
    ds_read_b128 v[80:83], v14 offset:4096
    ds_read_b128 v[84:87], v15 offset:4096
    s_waitcnt lgkmcnt(0)
    v_mfma_f32_16x16x32_bf16 v[36:39], v[56:59], v[20:23], 0
    v_mfma_f32_16x16x32_bf16 v[40:43], v[72:75], v[20:23], 0
    v_mfma_f32_16x16x32_bf16 v[36:39], v[60:63], v[24:27], v[36:39]
    v_mfma_f32_16x16x32_bf16 v[40:43], v[76:79], v[24:27], v[40:43]
    v_mfma_f32_16x16x32_bf16 v[36:39], v[64:67], v[28:31], v[36:39]
    v_mfma_f32_16x16x32_bf16 v[40:43], v[80:83], v[28:31], v[40:43]
    v_mfma_f32_16x16x32_bf16 v[36:39], v[68:71], v[32:35], v[36:39]
    v_mfma_f32_16x16x32_bf16 v[40:43], v[84:87], v[32:35], v[40:43]
    s_nop 6
    v_cvt_pk_bf16_f32 v44, v36, v37
    v_cvt_pk_bf16_f32 v45, v38, v39
    v_cvt_pk_bf16_f32 v46, v40, v41
    v_cvt_pk_bf16_f32 v47, v42, v43
    v_lshlrev_b32 v36, 16, v44
    v_and_b32 v37, 0xffff0000, v44
    v_lshlrev_b32 v38, 16, v45
    v_and_b32 v39, 0xffff0000, v45
    v_lshlrev_b32 v40, 16, v46
    v_and_b32 v41, 0xffff0000, v46
    v_lshlrev_b32 v42, 16, v47
    v_and_b32 v43, 0xffff0000, v47
    v_mul_f32 v36, 0x3db504f3, v36
    v_mul_f32 v37, 0x3db504f3, v37
    v_mul_f32 v38, 0x3db504f3, v38
    v_mul_f32 v39, 0x3db504f3, v39
    v_mul_f32 v40, 0x3db504f3, v40
    v_mul_f32 v41, 0x3db504f3, v41
    v_mul_f32 v42, 0x3db504f3, v42
    v_mul_f32 v43, 0x3db504f3, v43
    v_cvt_pk_bf16_f32 v44, v36, v37
    v_cvt_pk_bf16_f32 v45, v38, v39
    v_cvt_pk_bf16_f32 v46, v40, v41
    v_cvt_pk_bf16_f32 v47, v42, v43
    v_lshlrev_b32 v36, 16, v44
    v_and_b32 v37, 0xffff0000, v44
    v_lshlrev_b32 v38, 16, v45
    v_and_b32 v39, 0xffff0000, v45
    v_lshlrev_b32 v40, 16, v46
    v_and_b32 v41, 0xffff0000, v46
    v_lshlrev_b32 v42, 16, v47
    v_and_b32 v43, 0xffff0000, v47
    v_max3_f32 v18, v36, v37, v38
    v_max3_f32 v18, v18, v39, v40
    v_max3_f32 v18, v18, v41, v42
    v_max3_f32 v18, v18, v43, v9
    v_mov_b32 v19, v18
    s_nop 1
    v_permlane32_swap_b32 v19, v18
    v_max_f32 v18, v19, v18
    v_mov_b32 v19, v18
    s_nop 1
    v_permlane16_swap_b32 v19, v18
    v_max_f32 v18, v19, v18
    v_mul_f32 v16, s47, v18
    v_fma_f32 v11, v9, s47, -v16
    v_exp_f32 v11, v11
    v_mov_b32 v9, v18
    v_fma_f32 v36, v36, s47, -v16
    v_fma_f32 v37, v37, s47, -v16
    v_fma_f32 v38, v38, s47, -v16
    v_fma_f32 v39, v39, s47, -v16
    v_fma_f32 v40, v40, s47, -v16
    v_fma_f32 v41, v41, s47, -v16
    v_fma_f32 v42, v42, s47, -v16
    v_fma_f32 v43, v43, s47, -v16
    v_mov_b32_dpp v17, v11 row_newbcast:0 row_mask:0x5 bank_mask:0xf
    s_nop 1
    v_mov_b32_dpp v17, v11 row_newbcast:4 row_mask:0xa bank_mask:0xf
    v_exp_f32 v36, v36
    v_exp_f32 v37, v37
    v_exp_f32 v38, v38
    v_exp_f32 v39, v39
    v_exp_f32 v40, v40
    v_exp_f32 v41, v41
    v_exp_f32 v42, v42
    v_exp_f32 v43, v43
    v_mul_f32 v88, v17, v88
    v_mul_f32 v92, v17, v92
    v_mul_f32 v96, v17, v96
    v_mul_f32 v100, v17, v100
    v_mul_f32 v104, v17, v104
    v_mul_f32 v108, v17, v108
    v_mul_f32 v112, v17, v112
    v_mul_f32 v116, v17, v116
    v_cvt_pk_bf16_f32 v44, v36, v37
    v_cvt_pk_bf16_f32 v45, v38, v39
    v_cvt_pk_bf16_f32 v46, v40, v41
    v_cvt_pk_bf16_f32 v47, v42, v43
    v_add_f32 v36, v36, v37
    v_add_f32 v38, v38, v39
    v_add_f32 v40, v40, v41
    v_add_f32 v42, v42, v43
    v_add_f32 v36, v36, v38
    v_add_f32 v40, v40, v42
    v_add_f32 v36, v36, v40
    v_fma_f32 v10, v10, v11, v36
    s_waitcnt vmcnt(8)
    s_cmp_lg_u32 s63, 5
    s_cbranch_scc1 L_cw_29
    v_mov_b32 v19, v10
    s_nop 1
    v_permlane32_swap_b32 v19, v10
    v_add_f32 v10, v19, v10
    v_mov_b32 v19, v10
    s_nop 1
    v_permlane16_swap_b32 v19, v10
    v_add_f32 v10, v19, v10
    v_mul_f32 v9, s47, v9
    ds_write2_b32 v185, v9, v10 offset0:0 offset1:16
    s_waitcnt vmcnt(0)
L_cw_29:
    v_perm_b32 v48, v124, v120, s45
    v_perm_b32 v49, v132, v128, s45
    v_perm_b32 v50, v140, v136, s45
    v_perm_b32 v51, v148, v144, s45
    v_perm_b32 v52, v124, v120, s46
    v_perm_b32 v53, v132, v128, s46
    v_perm_b32 v54, v140, v136, s46
    v_perm_b32 v55, v148, v144, s46
    v_mfma_f32_16x16x32_bf16 v[88:91], v[44:47], v[48:51], v[88:91]
    v_perm_b32 v48, v125, v121, s45
    v_perm_b32 v49, v133, v129, s45
    v_perm_b32 v50, v141, v137, s45
    v_perm_b32 v51, v149, v145, s45
    v_mfma_f32_16x16x32_bf16 v[92:95], v[44:47], v[52:55], v[92:95]
    v_perm_b32 v52, v125, v121, s46
    v_perm_b32 v53, v133, v129, s46
    v_perm_b32 v54, v141, v137, s46
    v_perm_b32 v55, v149, v145, s46
    v_mfma_f32_16x16x32_bf16 v[96:99], v[44:47], v[48:51], v[96:99]
    v_perm_b32 v48, v126, v122, s45
    v_perm_b32 v49, v134, v130, s45
    v_perm_b32 v50, v142, v138, s45
    v_perm_b32 v51, v150, v146, s45
    v_mfma_f32_16x16x32_bf16 v[100:103], v[44:47], v[52:55], v[100:103]
    v_perm_b32 v52, v126, v122, s46
    v_perm_b32 v53, v134, v130, s46
    v_perm_b32 v54, v142, v138, s46
    v_perm_b32 v55, v150, v146, s46
    v_mfma_f32_16x16x32_bf16 v[104:107], v[44:47], v[48:51], v[104:107]
    v_perm_b32 v48, v127, v123, s45
    v_perm_b32 v49, v135, v131, s45
    v_perm_b32 v50, v143, v139, s45
    v_perm_b32 v51, v151, v147, s45
    v_mfma_f32_16x16x32_bf16 v[108:111], v[44:47], v[52:55], v[108:111]
    v_perm_b32 v52, v127, v123, s46
    v_perm_b32 v53, v135, v131, s46
    v_perm_b32 v54, v143, v139, s46
    v_perm_b32 v55, v151, v147, s46
    v_mfma_f32_16x16x32_bf16 v[112:115], v[44:47], v[48:51], v[112:115]
    s_nop 0
    v_mfma_f32_16x16x32_bf16 v[116:119], v[44:47], v[52:55], v[116:119]
    s_cmp_le_u32 s63, 5
    s_cbranch_scc1 L_A_fin
    s_waitcnt vmcnt(4)
    ds_read_b128 v[56:59], v12 offset:8192
    ds_read_b128 v[60:63], v13 offset:8192
    ds_read_b128 v[64:67], v14 offset:8192
    ds_read_b128 v[68:71], v15 offset:8192
    v_mov_b32 v40, 0xff800000
    v_mov_b32 v41, 0xff800000
    v_mov_b32 v42, 0xff800000
    v_mov_b32 v43, 0xff800000
    s_waitcnt lgkmcnt(0)
    v_mfma_f32_16x16x32_bf16 v[36:39], v[56:59], v[20:23], 0
    v_mfma_f32_16x16x32_bf16 v[36:39], v[60:63], v[24:27], v[36:39]
    v_mfma_f32_16x16x32_bf16 v[36:39], v[64:67], v[28:31], v[36:39]
    v_mfma_f32_16x16x32_bf16 v[36:39], v[68:71], v[32:35], v[36:39]
    s_nop 7
    v_cvt_pk_bf16_f32 v44, v36, v37
    v_cvt_pk_bf16_f32 v45, v38, v39
    v_lshlrev_b32 v36, 16, v44
    v_and_b32 v37, 0xffff0000, v44
    v_lshlrev_b32 v38, 16, v45
    v_and_b32 v39, 0xffff0000, v45
    v_mul_f32 v36, 0x3db504f3, v36
    v_mul_f32 v37, 0x3db504f3, v37
    v_mul_f32 v38, 0x3db504f3, v38
    v_mul_f32 v39, 0x3db504f3, v39
    v_cvt_pk_bf16_f32 v44, v36, v37
    v_cvt_pk_bf16_f32 v45, v38, v39
    v_lshlrev_b32 v36, 16, v44
    v_and_b32 v37, 0xffff0000, v44
    v_lshlrev_b32 v38, 16, v45
    v_and_b32 v39, 0xffff0000, v45
    v_max3_f32 v18, v36, v37, v38
    v_max3_f32 v18, v18, v39, v40
    v_max3_f32 v18, v18, v41, v42
    v_max3_f32 v18, v18, v43, v9
    v_mov_b32 v19, v18
    s_nop 1
    v_permlane32_swap_b32 v19, v18
    v_max_f32 v18, v19, v18
    v_mov_b32 v19, v18
    s_nop 1
    v_permlane16_swap_b32 v19, v18
    v_max_f32 v18, v19, v18
    v_mul_f32 v16, s47, v18
    v_fma_f32 v11, v9, s47, -v16
    v_exp_f32 v11, v11
    v_mov_b32 v9, v18
    v_fma_f32 v36, v36, s47, -v16
    v_fma_f32 v37, v37, s47, -v16
    v_fma_f32 v38, v38, s47, -v16
    v_fma_f32 v39, v39, s47, -v16
    v_fma_f32 v40, v40, s47, -v16
    v_fma_f32 v41, v41, s47, -v16
    v_fma_f32 v42, v42, s47, -v16
    v_fma_f32 v43, v43, s47, -v16
    v_mov_b32_dpp v17, v11 row_newbcast:0 row_mask:0x5 bank_mask:0xf
    s_nop 1
    v_mov_b32_dpp v17, v11 row_newbcast:4 row_mask:0xa bank_mask:0xf
    v_exp_f32 v36, v36
    v_exp_f32 v37, v37
    v_exp_f32 v38, v38
    v_exp_f32 v39, v39
    v_exp_f32 v40, v40
    v_exp_f32 v41, v41
    v_exp_f32 v42, v42
    v_exp_f32 v43, v43
    v_mul_f32 v88, v17, v88
    v_mul_f32 v92, v17, v92
    v_mul_f32 v96, v17, v96
    v_mul_f32 v100, v17, v100
    v_mul_f32 v104, v17, v104
    v_mul_f32 v108, v17, v108
    v_mul_f32 v112, v17, v112
    v_mul_f32 v116, v17, v116
    v_cvt_pk_bf16_f32 v44, v36, v37
    v_cvt_pk_bf16_f32 v45, v38, v39
    v_cvt_pk_bf16_f32 v46, v40, v41
    v_cvt_pk_bf16_f32 v47, v42, v43
    v_add_f32 v36, v36, v37
    v_add_f32 v38, v38, v39
    v_add_f32 v40, v40, v41
    v_add_f32 v42, v42, v43
    v_add_f32 v36, v36, v38
    v_add_f32 v40, v40, v42
    v_add_f32 v36, v36, v40
    v_fma_f32 v10, v10, v11, v36
    v_mov_b32 v19, v10
    s_nop 1
    v_permlane32_swap_b32 v19, v10
    v_add_f32 v10, v19, v10
    v_mov_b32 v19, v10
    s_nop 1
    v_permlane16_swap_b32 v19, v10
    v_add_f32 v10, v19, v10
    v_mul_f32 v9, s47, v9
    ds_write2_b32 v185, v9, v10 offset0:0 offset1:16
    s_waitcnt vmcnt(0)
    v_perm_b32 v48, v156, v152, s45
    v_perm_b32 v49, v164, v160, s45
    v_perm_b32 v52, v156, v152, s46
    v_perm_b32 v53, v164, v160, s46
    v_mfma_f32_16x16x16_bf16 v[88:91], v[44:45], v[48:49], v[88:91]
    v_perm_b32 v48, v157, v153, s45
    v_perm_b32 v49, v165, v161, s45
    v_mfma_f32_16x16x16_bf16 v[92:95], v[44:45], v[52:53], v[92:95]
    v_perm_b32 v52, v157, v153, s46
    v_perm_b32 v53, v165, v161, s46
    v_mfma_f32_16x16x16_bf16 v[96:99], v[44:45], v[48:49], v[96:99]
    v_perm_b32 v48, v158, v154, s45
    v_perm_b32 v49, v166, v162, s45
    v_mfma_f32_16x16x16_bf16 v[100:103], v[44:45], v[52:53], v[100:103]
    v_perm_b32 v52, v158, v154, s46
    v_perm_b32 v53, v166, v162, s46
    v_mfma_f32_16x16x16_bf16 v[104:107], v[44:45], v[48:49], v[104:107]
    v_perm_b32 v48, v159, v155, s45
    v_perm_b32 v49, v167, v163, s45
    v_mfma_f32_16x16x16_bf16 v[108:111], v[44:45], v[52:53], v[108:111]
    v_perm_b32 v52, v159, v155, s46
    v_perm_b32 v53, v167, v163, s46
    v_mfma_f32_16x16x16_bf16 v[112:115], v[44:45], v[48:49], v[112:115]
    s_nop 0
    v_mfma_f32_16x16x16_bf16 v[116:119], v[44:45], v[52:53], v[116:119]
L_A_fin:
    ds_write2_b32 v184, v88, v92 offset0:0 offset1:36
    ds_write2_b32 v184, v96, v100 offset0:72 offset1:108
    s_nop 0
    ds_write2_b32 v184, v104, v108 offset0:144 offset1:180
    s_nop 3
    ds_write2_b32 v184, v112, v116 offset0:216 offset1:252
    s_waitcnt lgkmcnt(0)
    s_barrier
    s_cmp_ge_u32 s44, 4
    s_cbranch_scc1 L_A_done
    ds_read2_b32 v[44:45], v187 offset0:0 offset1:16
    ds_read_b32 v36, v186 offset:0
    ds_read_b32 v37, v186 offset:1152
    ds_read_b32 v38, v186 offset:2304
    ds_read_b32 v39, v186 offset:3456
    ds_read_b32 v40, v186 offset:4608
    ds_read_b32 v41, v186 offset:5760
    ds_read_b32 v42, v186 offset:6912
    ds_read_b32 v43, v186 offset:8064
    s_waitcnt lgkmcnt(8)
    v_max_f32_dpp v9, v44, v44 quad_perm:[1,0,3,2] row_mask:0xf bank_mask:0xf
    s_nop 1
    v_max_f32_dpp v9, v9, v9 quad_perm:[2,3,0,1] row_mask:0xf bank_mask:0xf
    s_nop 1
    v_max_f32_dpp v9, v9, v9 row_half_mirror row_mask:0xf bank_mask:0xf
    v_sub_f32 v44, v44, v9
    v_exp_f32 v44, v44
    s_nop 0
    v_mul_f32 v10, v44, v45
    s_nop 1
    v_add_f32_dpp v10, v10, v10 quad_perm:[1,0,3,2] row_mask:0xf bank_mask:0xf
    s_nop 1
    v_add_f32_dpp v10, v10, v10 quad_perm:[2,3,0,1] row_mask:0xf bank_mask:0xf
    s_nop 1
    v_add_f32_dpp v10, v10, v10 row_half_mirror row_mask:0xf bank_mask:0xf
    v_rcp_f32 v11, v10
    v_log_f32 v10, v10
    v_mul_f32 v44, v44, v11
    v_add_f32 v190, v10, v9
    s_waitcnt lgkmcnt(0)
    v_mul_f32_dpp v17, v44, v36 row_newbcast:0 row_mask:0xf bank_mask:0xf
    v_mul_f32_dpp v16, v44, v37 row_newbcast:1 row_mask:0xf bank_mask:0xf
    v_mul_f32_dpp v18, v44, v38 row_newbcast:2 row_mask:0xf bank_mask:0xf
    v_fmac_f32_dpp v17, v44, v39 row_newbcast:3 row_mask:0xf bank_mask:0xf
    v_fmac_f32_dpp v16, v44, v40 row_newbcast:4 row_mask:0xf bank_mask:0xf
    v_fmac_f32_dpp v18, v44, v41 row_newbcast:5 row_mask:0xf bank_mask:0xf
    v_fmac_f32_dpp v17, v44, v42 row_newbcast:6 row_mask:0xf bank_mask:0xf
    v_fmac_f32_dpp v16, v44, v43 row_newbcast:7 row_mask:0xf bank_mask:0xf
    v_add_f32 v17, v17, v18
    v_add_f32 v17, v17, v16
    v_bfi_b32 v17, s55, v191, v17
    s_cmp_lg_u32 s42, 0
    s_cbranch_scc1 L_fl_30
    buffer_store_dword v17, v188, s[8:11], s53 offen sc1
    s_mov_b64 exec, 1
    buffer_store_dwordx2 v[190:191], v188, s[8:11], s54 offen sc1
    s_mov_b64 exec, -1
    s_branch L_fl_30d
L_fl_30:
    buffer_store_dword v17, v188, s[8:11], s53 offen
    s_mov_b64 exec, 1
    buffer_store_dwordx2 v[190:191], v188, s[8:11], s54 offen
    s_mov_b64 exec, -1
L_fl_30d:
L_A_done:
    s_endpgm
    .p2align 6
L_B:
    s_load_dwordx2 s[20:21], s[0:1], 48
    s_load_dwordx2 s[24:25], s[0:1], 72
    s_load_dwordx2 s[28:29], s[0:1], 80
    s_load_dwordx2 s[32:33], s[0:1], 32
    s_load_dwordx2 s[36:37], s[0:1], 88
    s_load_dwordx2 s[12:13], s[0:1], 96
    s_mov_b32 s6, 2304
    s_mov_b32 s7, 0x20000
    s_mov_b32 s10, 268435456
    s_mov_b32 s11, 0x20000
    s_mov_b32 s22, 16777216
    s_mov_b32 s23, 0x20000
    s_mov_b32 s26, 4194304
    s_mov_b32 s27, 0x20000
    s_mov_b32 s30, 4718592
    s_mov_b32 s31, 0x20000
    s_mov_b32 s34, 4718592
    s_mov_b32 s35, 0x20000
    s_mov_b32 s38, 1152
    s_mov_b32 s39, 0x20000
    s_mov_b32 s14, 2304
    s_mov_b32 s15, 0x20000
    v_lshrrev_b32 v2, 6, v0
    v_and_b32 v1, 63, v0
    v_readfirstlane_b32 s44, v2
    v_lshrrev_b32 v2, 4, v1
    v_and_b32 v3, 15, v1
    s_mov_b32 s45, 0x05040100
    s_mov_b32 s46, 0x07060302
    s_mov_b32 s47, 0x3e0293ee
    s_and_b32 s16, s2, 7
    s_lshr_b32 s17, s2, 3
    s_and_b32 s60, s16, 1
    s_lshr_b32 s61, s16, 1
    s_lshl_b32 s62, s60, 23
    s_lshl_b32 s51, s61, 21
    s_add_u32 s62, s62, s51
    s_lshl_b32 s51, s17, 18
    s_add_u32 s62, s62, s51
    s_lshl_b32 s51, s44, 12
    s_add_u32 s62, s62, s51
    s_lshl_b32 s18, s16, 3
    s_add_u32 s18, s18, s17
    s_and_b32 s58, s17, 1
    s_lshr_b32 s49, s17, 2
    s_lshl_b32 s49, s49, 3
    s_add_u32 s49, s49, s16
    s_lshl_b32 s49, s49, 2
    s_and_b32 s59, s17, 3
    s_add_u32 s59, s59, s49
    s_lshr_b32 s57, s59, 1
    s_lshl_b32 s63, s57, 8
    v_lshlrev_b32 v4, 4, v1
    s_and_b32 s51, s44, 3
    s_lshl_b32 s51, s51, 1
    s_lshr_b32 s51, 0x78, s51
    s_and_b32 s51, s51, 3
    s_lshl_b32 s51, s51, 4
    v_xor_b32 v7, s51, v4
    s_waitcnt lgkmcnt(0)
    s_cmp_eq_u32 s44, 7
    s_cbranch_scc1 L_B_svc
    s_setprio 2
    s_cmp_lg_u32 s44, 6
    s_cbranch_scc1 L_B_w05
    s_getpc_b64 s[70:71]
L_pc_30:
    s_lshr_b32 s72, s2, 3
    s_and_b32 s72, s72, 7
    s_mul_i32 s72, s72, 4096
    s_sub_u32 s70, s70, L_pc_30-gated_mix__gqa_block_cached__compressed_kv_cla__decode_kernel
    s_subb_u32 s71, s71, 0
    v_lshl_add_u32 v5, v1, 4, s72
    v_min_u32 v64, L_codeend-gated_mix__gqa_block_cached__compressed_kv_cla__decode_kernel-16, v5
    global_load_dwordx4 v[60:63], v64, s[70:71]
    v_add_u32 v5, 1024, v5
    v_min_u32 v64, L_codeend-gated_mix__gqa_block_cached__compressed_kv_cla__decode_kernel-16, v5
    global_load_dwordx4 v[60:63], v64, s[70:71]
    v_add_u32 v5, 1024, v5
    v_min_u32 v64, L_codeend-gated_mix__gqa_block_cached__compressed_kv_cla__decode_kernel-16, v5
    global_load_dwordx4 v[60:63], v64, s[70:71]
    v_add_u32 v5, 1024, v5
    v_min_u32 v64, L_codeend-gated_mix__gqa_block_cached__compressed_kv_cla__decode_kernel-16, v5
    global_load_dwordx4 v[60:63], v64, s[70:71]
    v_and_b32 v5, 31, v1
    v_mul_u32_u24 v5, 36, v5
    v_lshrrev_b32 v6, 5, v1
    v_mul_u32_u24 v6, 1152, v6
    v_add_u32 v6, v6, v5
    buffer_load_dwordx4 v[156:159], v6, s[4:7], 0 offen
    buffer_load_dwordx4 v[160:163], v6, s[4:7], 0 offen offset:16
    buffer_load_dword v164, v6, s[4:7], 0 offen offset:32
    buffer_load_dwordx4 v[168:171], v5, s[36:39], 0 offen
    buffer_load_dwordx4 v[172:175], v5, s[36:39], 0 offen offset:16
    buffer_load_dword v176, v5, s[36:39], 0 offen offset:32
    v_mov_b32 v32, 0
    s_waitcnt vmcnt(0)
    v_mov_b32 v33, 0x3f803f80
    v_lshlrev_b32 v40, 16, v156
    v_lshlrev_b32 v41, 16, v168
    v_and_b32 v42, 0xffff0000, v156
    v_and_b32 v43, 0xffff0000, v168
    v_mul_f32 v40, v40, v41
    v_mul_f32 v42, v42, v43
    v_cvt_pk_bf16_f32 v156, v40, v42
    v_lshlrev_b32 v40, 16, v157
    v_lshlrev_b32 v41, 16, v169
    v_and_b32 v42, 0xffff0000, v157
    v_and_b32 v43, 0xffff0000, v169
    v_mul_f32 v40, v40, v41
    v_mul_f32 v42, v42, v43
    v_cvt_pk_bf16_f32 v157, v40, v42
    v_lshlrev_b32 v40, 16, v158
    v_lshlrev_b32 v41, 16, v170
    v_and_b32 v42, 0xffff0000, v158
    v_and_b32 v43, 0xffff0000, v170
    v_mul_f32 v40, v40, v41
    v_mul_f32 v42, v42, v43
    v_cvt_pk_bf16_f32 v158, v40, v42
    v_lshlrev_b32 v40, 16, v159
    v_lshlrev_b32 v41, 16, v171
    v_and_b32 v42, 0xffff0000, v159
    v_and_b32 v43, 0xffff0000, v171
    v_mul_f32 v40, v40, v41
    v_mul_f32 v42, v42, v43
    v_cvt_pk_bf16_f32 v159, v40, v42
    v_lshlrev_b32 v40, 16, v160
    v_lshlrev_b32 v41, 16, v172
    v_and_b32 v42, 0xffff0000, v160
    v_and_b32 v43, 0xffff0000, v172
    v_mul_f32 v40, v40, v41
    v_mul_f32 v42, v42, v43
    v_cvt_pk_bf16_f32 v160, v40, v42
    v_lshlrev_b32 v40, 16, v161
    v_lshlrev_b32 v41, 16, v173
    v_and_b32 v42, 0xffff0000, v161
    v_and_b32 v43, 0xffff0000, v173
    v_mul_f32 v40, v40, v41
    v_mul_f32 v42, v42, v43
    v_cvt_pk_bf16_f32 v161, v40, v42
    v_lshlrev_b32 v40, 16, v162
    v_lshlrev_b32 v41, 16, v174
    v_and_b32 v42, 0xffff0000, v162
    v_and_b32 v43, 0xffff0000, v174
    v_mul_f32 v40, v40, v41
    v_mul_f32 v42, v42, v43
    v_cvt_pk_bf16_f32 v162, v40, v42
    v_lshlrev_b32 v40, 16, v163
    v_lshlrev_b32 v41, 16, v175
    v_and_b32 v42, 0xffff0000, v163
    v_and_b32 v43, 0xffff0000, v175
    v_mul_f32 v40, v40, v41
    v_mul_f32 v42, v42, v43
    v_cvt_pk_bf16_f32 v163, v40, v42
    v_lshlrev_b32 v40, 16, v164
    v_lshlrev_b32 v41, 16, v176
    v_and_b32 v42, 0xffff0000, v164
    v_and_b32 v43, 0xffff0000, v176
    v_mul_f32 v40, v40, v41
    v_mul_f32 v42, v42, v43
    v_cvt_pk_bf16_f32 v164, v40, v42
    v_dot2c_f32_bf16 v32, v156, v33
    v_dot2c_f32_bf16 v32, v157, v33
    v_dot2c_f32_bf16 v32, v158, v33
    v_dot2c_f32_bf16 v32, v159, v33
    v_dot2c_f32_bf16 v32, v160, v33
    v_dot2c_f32_bf16 v32, v161, v33
    v_dot2c_f32_bf16 v32, v162, v33
    v_dot2c_f32_bf16 v32, v163, v33
    v_dot2c_f32_bf16 v32, v164, v33
    s_nop 2
    v_add_f32_dpp v32, v32, v32 row_ror:8 row_mask:0xf bank_mask:0xf
    s_nop 1
    v_add_f32_dpp v32, v32, v32 row_ror:4 row_mask:0xf bank_mask:0xf
    s_nop 1
    v_add_f32_dpp v32, v32, v32 row_ror:2 row_mask:0xf bank_mask:0xf
    s_nop 1
    v_add_f32_dpp v32, v32, v32 row_ror:1 row_mask:0xf bank_mask:0xf
    v_mov_b32 v5, v32
    s_nop 1
    v_permlane16_swap_b32 v5, v32
    v_add_f32 v32, v5, v32
    v_cvt_pk_bf16_f32 v32, v32, v32
    v_lshlrev_b32 v32, 16, v32
    v_mul_f32 v32, 0xbfb8aa3b, v32
    v_exp_f32 v32, v32
    s_nop 0
    v_add_f32 v32, 1.0, v32
    v_rcp_f32 v12, v32
    s_nop 0
    v_cvt_pk_bf16_f32 v12, v12, v12
    v_lshlrev_b32 v12, 16, v12
L_B_w05:
    s_lshl_b32 s51, s44, 12
    s_mov_b32 m0, s51
    v_xor_b32 v6, 0, v7
    s_waitcnt vmcnt(3)
    buffer_load_dwordx4 v6, s[20:23], s62 offen offset:0 nt lds
    v_xor_b32 v6, 64, v7
    s_waitcnt vmcnt(3)
    buffer_load_dwordx4 v6, s[20:23], s62 offen offset:1024 nt lds
    v_xor_b32 v6, 128, v7
    s_waitcnt vmcnt(3)
    buffer_load_dwordx4 v6, s[20:23], s62 offen offset:2048 nt lds
    v_xor_b32 v6, 192, v7
    s_waitcnt vmcnt(3)
    buffer_load_dwordx4 v6, s[20:23], s62 offen offset:3072 nt lds
    s_add_u32 m0, s51, 32768
    s_add_u32 s52, s62, 32768
    v_xor_b32 v6, 0, v7
    s_waitcnt vmcnt(3)
    buffer_load_dwordx4 v6, s[20:23], s52 offen offset:0 nt lds
    v_xor_b32 v6, 64, v7
    s_waitcnt vmcnt(3)
    buffer_load_dwordx4 v6, s[20:23], s52 offen offset:1024 nt lds
    v_xor_b32 v6, 128, v7
    s_waitcnt vmcnt(3)
    buffer_load_dwordx4 v6, s[20:23], s52 offen offset:2048 nt lds
    v_xor_b32 v6, 192, v7
    s_waitcnt vmcnt(3)
    buffer_load_dwordx4 v6, s[20:23], s52 offen offset:3072 nt lds
    s_add_u32 s49, s62, 65536
    s_add_u32 s51, s51, 65536
    s_mov_b32 m0, s51
    v_xor_b32 v6, 0, v7
    s_waitcnt vmcnt(3)
    buffer_load_dwordx4 v6, s[20:23], s49 offen offset:0 nt lds
    v_xor_b32 v6, 64, v7
    s_waitcnt vmcnt(3)
    buffer_load_dwordx4 v6, s[20:23], s49 offen offset:1024 nt lds
    v_xor_b32 v6, 128, v7
    s_waitcnt vmcnt(3)
    buffer_load_dwordx4 v6, s[20:23], s49 offen offset:2048 nt lds
    v_xor_b32 v6, 192, v7
    s_waitcnt vmcnt(3)
    buffer_load_dwordx4 v6, s[20:23], s49 offen offset:3072 nt lds
    s_add_u32 m0, s51, 32768
    s_add_u32 s52, s49, 32768
    v_xor_b32 v6, 0, v7
    s_waitcnt vmcnt(3)
    buffer_load_dwordx4 v6, s[20:23], s52 offen offset:0 nt lds
    v_xor_b32 v6, 64, v7
    s_waitcnt vmcnt(3)
    buffer_load_dwordx4 v6, s[20:23], s52 offen offset:1024 nt lds
    v_xor_b32 v6, 128, v7
    s_waitcnt vmcnt(3)
    buffer_load_dwordx4 v6, s[20:23], s52 offen offset:2048 nt lds
    v_xor_b32 v6, 192, v7
    s_waitcnt vmcnt(3)
    buffer_load_dwordx4 v6, s[20:23], s52 offen offset:3072 nt lds
    s_setprio 1
    s_add_u32 s49, s62, 131072
    v_xor_b32 v6, 0, v7
    s_waitcnt vmcnt(3)
    buffer_load_dwordx4 v[124:127], v6, s[20:23], s49 offen offset:0 nt
    v_xor_b32 v6, 64, v7
    s_waitcnt vmcnt(3)
    buffer_load_dwordx4 v[128:131], v6, s[20:23], s49 offen offset:1024 nt
    v_xor_b32 v6, 128, v7
    s_waitcnt vmcnt(3)
    buffer_load_dwordx4 v[132:135], v6, s[20:23], s49 offen offset:2048 nt
    v_xor_b32 v6, 192, v7
    s_waitcnt vmcnt(3)
    buffer_load_dwordx4 v[136:139], v6, s[20:23], s49 offen offset:3072 nt
    s_add_u32 s52, s49, 32768
    v_xor_b32 v6, 0, v7
    s_waitcnt vmcnt(3)
    buffer_load_dwordx4 v[140:143], v6, s[20:23], s52 offen offset:0 nt
    v_xor_b32 v6, 64, v7
    s_waitcnt vmcnt(3)
    buffer_load_dwordx4 v[144:147], v6, s[20:23], s52 offen offset:1024 nt
    v_xor_b32 v6, 128, v7
    s_waitcnt vmcnt(3)
    buffer_load_dwordx4 v[148:151], v6, s[20:23], s52 offen offset:2048 nt
    v_xor_b32 v6, 192, v7
    s_waitcnt vmcnt(3)
    buffer_load_dwordx4 v[152:155], v6, s[20:23], s52 offen offset:3072 nt
    s_setprio 0
    s_branch L_B_bv
L_B_svc:
    s_setprio 3
    v_mov_b32 v61, 0
    s_load_dword s64, s[8:9], 0
    v_mov_b32 v64, -1
    v_mov_b32 v65, -1
    v_mov_b32 v66, -1
    v_mov_b32 v67, -1
    s_lshl_b32 s49, s58, 15
    s_lshl_b32 s50, s57, 10
    s_add_u32 s49, s49, s50
    s_add_u32 s49, s49, 524288
    buffer_store_dwordx4 v[64:67], v4, s[8:11], s49 offen sc1
    s_lshl_b32 s50, s18, 7
    s_add_u32 s50, s50, 4096
    s_getreg_b32 s43, hwreg(HW_REG_XCC_ID, 0, 4)
    s_waitcnt lgkmcnt(0)
    s_mul_i32 s64, s64, 0x9e3779b1
    s_add_u32 s64, s64, 0x7f4a7c15
    v_mov_b32 v14, s64
    v_mov_b32 v15, s43
    s_waitcnt vmcnt(0)
    s_mov_b64 exec, 1
    buffer_store_dwordx2 v[14:15], v61, s[8:11], s50 offen sc1
    s_mov_b64 exec, -1
    s_lshl_b32 s51, s44, 12
    s_mov_b32 m0, s51
    v_xor_b32 v6, 0, v7
    buffer_load_dwordx4 v6, s[20:23], s62 offen offset:0 nt lds
    v_xor_b32 v6, 64, v7
    buffer_load_dwordx4 v6, s[20:23], s62 offen offset:1024 nt lds
    v_xor_b32 v6, 128, v7
    buffer_load_dwordx4 v6, s[20:23], s62 offen offset:2048 nt lds
    v_xor_b32 v6, 192, v7
    buffer_load_dwordx4 v6, s[20:23], s62 offen offset:3072 nt lds
    s_add_u32 m0, s51, 32768
    s_add_u32 s52, s62, 32768
    v_xor_b32 v6, 0, v7
    buffer_load_dwordx4 v6, s[20:23], s52 offen offset:0 nt lds
    v_xor_b32 v6, 64, v7
    buffer_load_dwordx4 v6, s[20:23], s52 offen offset:1024 nt lds
    v_xor_b32 v6, 128, v7
    buffer_load_dwordx4 v6, s[20:23], s52 offen offset:2048 nt lds
    v_xor_b32 v6, 192, v7
    buffer_load_dwordx4 v6, s[20:23], s52 offen offset:3072 nt lds
    s_add_u32 s49, s62, 65536
    s_add_u32 s51, s51, 65536
    s_mov_b32 m0, s51
    v_xor_b32 v6, 0, v7
    buffer_load_dwordx4 v6, s[20:23], s49 offen offset:0 nt lds
    v_xor_b32 v6, 64, v7
    buffer_load_dwordx4 v6, s[20:23], s49 offen offset:1024 nt lds
    v_xor_b32 v6, 128, v7
    buffer_load_dwordx4 v6, s[20:23], s49 offen offset:2048 nt lds
    v_xor_b32 v6, 192, v7
    buffer_load_dwordx4 v6, s[20:23], s49 offen offset:3072 nt lds
    s_add_u32 m0, s51, 32768
    s_add_u32 s52, s49, 32768
    v_xor_b32 v6, 0, v7
    buffer_load_dwordx4 v6, s[20:23], s52 offen offset:0 nt lds
    v_xor_b32 v6, 64, v7
    buffer_load_dwordx4 v6, s[20:23], s52 offen offset:1024 nt lds
    v_xor_b32 v6, 128, v7
    buffer_load_dwordx4 v6, s[20:23], s52 offen offset:2048 nt lds
    v_xor_b32 v6, 192, v7
    buffer_load_dwordx4 v6, s[20:23], s52 offen offset:3072 nt lds
    v_lshlrev_b32 v5, 7, v1
    s_mov_b32 s50, 4096
    buffer_load_dwordx2 v[32:33], v5, s[8:11], s50 offen sc1
    s_add_u32 s49, s62, 131072
    v_xor_b32 v6, 0, v7
    buffer_load_dwordx4 v[124:127], v6, s[20:23], s49 offen offset:0 nt
    v_xor_b32 v6, 64, v7
    buffer_load_dwordx4 v[128:131], v6, s[20:23], s49 offen offset:1024 nt
    v_xor_b32 v6, 128, v7
    buffer_load_dwordx4 v[132:135], v6, s[20:23], s49 offen offset:2048 nt
    v_xor_b32 v6, 192, v7
    buffer_load_dwordx4 v[136:139], v6, s[20:23], s49 offen offset:3072 nt
    s_add_u32 s52, s49, 32768
    v_xor_b32 v6, 0, v7
    buffer_load_dwordx4 v[140:143], v6, s[20:23], s52 offen offset:0 nt
    v_xor_b32 v6, 64, v7
    buffer_load_dwordx4 v[144:147], v6, s[20:23], s52 offen offset:1024 nt
    v_xor_b32 v6, 128, v7
    buffer_load_dwordx4 v[148:151], v6, s[20:23], s52 offen offset:2048 nt
    v_xor_b32 v6, 192, v7
    buffer_load_dwordx4 v[152:155], v6, s[20:23], s52 offen offset:3072 nt
    s_mov_b32 s48, 524288
    s_waitcnt vmcnt(8)
    s_branch L_B_vc
L_B_vf:
    buffer_load_dwordx2 v[32:33], v5, s[8:11], s50 offen sc1
    s_waitcnt vmcnt(0)
L_B_vc:
    v_cmp_ne_u32 vcc, v32, v14
    s_nop 1
    s_cbranch_vccz L_ok_32
    s_sub_u32 s48, s48, 1
    s_cbranch_scc1 L_end
    s_sleep 1
    s_branch L_B_vf
L_ok_32:
    v_cmp_ne_u32 vcc, v33, v15
    s_lshl_b32 s49, s16, 3
    s_nop 0
    s_lshr_b64 s[54:55], vcc, s49
    s_and_b32 s54, s54, 0xff
    s_cselect_b32 s54, 0, 1
    v_mov_b32 v15, s54
    s_setprio 0
L_B_bv:
    s_barrier
    s_lshl_b32 s49, s60, 15
    s_lshl_b32 s50, s44, 12
    s_add_u32 s49, s49, s50
    s_add_u32 s49, s49, 524288
    s_lshl_b32 s51, s44, 6
    s_and_b32 s51, s51, 0xff
    v_xor_b32 v5, s51, v4
    s_add_u32 s50, s50, 131072
    v_add_u32 v5, s50, v5
    s_mov_b32 s48, 524288
L_B_qp:
    buffer_load_dwordx4 v[60:63], v4, s[8:11], s49 offen offset:0 sc1
    buffer_load_dwordx4 v[64:67], v4, s[8:11], s49 offen offset:1024 sc1
    buffer_load_dwordx4 v[68:71], v4, s[8:11], s49 offen offset:2048 sc1
    buffer_load_dwordx4 v[72:75], v4, s[8:11], s49 offen offset:3072 sc1
    s_waitcnt vmcnt(0)
    v_max3_u32 v6, v60, v61, v62
    v_max3_u32 v6, v6, v63, v64
    v_max3_u32 v6, v6, v65, v66
    v_max3_u32 v6, v6, v67, v68
    v_max3_u32 v6, v6, v69, v70
    v_max3_u32 v6, v6, v71, v72
    v_max3_u32 v6, v6, v73, v74
    v_max_u32 v6, v6, v75
    v_cmp_eq_u32 vcc, -1, v6
    s_nop 1
    s_cbranch_vccz L_ok_33
    s_sub_u32 s48, s48, 1
    s_cbranch_scc1 L_end
    s_sleep 1
    s_branch L_B_qp
L_ok_33:
    ds_write_b128 v5, v[60:63] offset:0
    v_xor_b32 v6, 16, v5
    ds_write_b128 v6, v[64:67] offset:1024
    v_xor_b32 v6, 32, v5
    ds_write_b128 v6, v[68:71] offset:2048
    v_xor_b32 v6, 48, v5
    ds_write_b128 v6, v[72:75] offset:3072
    s_lshr_b32 s49, s44, 2
    s_and_b32 s50, s44, 3
    v_xor_b32 v5, v2, v3
    v_lshlrev_b32 v5, 4, v5
    v_lshl_or_b32 v5, v3, 10, v5
    s_lshl_b32 s51, s49, 14
    s_add_u32 s51, s51, 131072
    v_add_u32 v20, s51, v5
    v_xor_b32 v21, 64, v20
    v_xor_b32 v22, 0x80, v20
    v_xor_b32 v23, 0xc0, v20
    s_waitcnt lgkmcnt(0)
    s_barrier
    ds_read_b128 v[156:159], v20 offset:0
    ds_read_b128 v[160:163], v21 offset:0
    ds_read_b128 v[164:167], v22 offset:0
    ds_read_b128 v[168:171], v23 offset:0
    ds_read_b128 v[172:175], v20 offset:256
    ds_read_b128 v[176:179], v21 offset:256
    ds_read_b128 v[180:183], v22 offset:256
    ds_read_b128 v[184:187], v23 offset:256
    ds_read_b128 v[188:191], v20 offset:512
    ds_read_b128 v[192:195], v21 offset:512
    ds_read_b128 v[196:199], v22 offset:512
    ds_read_b128 v[200:203], v23 offset:512
    ds_read_b128 v[204:207], v20 offset:768
    ds_read_b128 v[208:211], v21 offset:768
    ds_read_b128 v[212:215], v22 offset:768
    ds_read_b128 v[216:219], v23 offset:768
    s_mov_b32 s52, 0x78
    v_lshrrev_b32 v5, 2, v3
    v_lshlrev_b32 v5, 1, v5
    v_bfe_u32 v5, s52, v5, 2
    v_and_b32 v6, 3, v3
    v_lshl_or_b32 v5, v6, 2, v5
    v_xor_b32 v5, v5, v2
    v_lshlrev_b32 v5, 4, v5
    v_lshl_or_b32 v5, v3, 10, v5
    s_lshl_b32 s51, s50, 14
    v_add_u32 v16, s51, v5
    v_xor_b32 v17, 64, v16
    v_xor_b32 v18, 0x80, v16
    v_xor_b32 v19, 0xc0, v16
    s_lshl_b32 s51, s49, 4
    v_add_u32 v5, s51, v3
    v_mul_u32_u24 v30, 272, v5
    v_lshl_add_u32 v30, v2, 3, v30
    s_lshl_b32 s51, s50, 5
    s_add_u32 s51, s51, 147456
    v_add_u32 v30, s51, v30
    v_lshlrev_b32 v10, 4, v5
    v_add_u32 v10, 156160, v10
    s_lshl_b32 s51, s50, 2
    v_add_u32 v9, s51, v10
    v_and_b32 v5, 31, v1
    v_lshlrev_b32 v11, 4, v5
    v_add_u32 v11, 156160, v11
    v_mul_u32_u24 v31, 272, v5
    v_lshrrev_b32 v6, 5, v1
    v_lshl_add_u32 v31, v6, 4, v31
    v_add_u32 v31, 147456, v31
    s_waitcnt lgkmcnt(0)
    v_bfe_u32 v5, v1, 2, 2
    v_lshl_add_u32 v21, v6, 3, v5
    v_lshlrev_b32 v21, 10, v21
    v_lshlrev_b32 v5, 2, v5
    v_mad_u32_u24 v5, v6, 3, v5
    v_bfe_u32 v6, v1, 4, 1
    v_lshlrev_b32 v6, 1, v6
    v_bfe_u32 v22, v1, 1, 1
    v_add_u32 v6, v6, v22
    s_lshl_b32 s51, s44, 3
    v_add_u32 v6, s51, v6
    v_xor_b32 v6, v6, v5
    v_lshl_or_b32 v20, v6, 4, v21
    v_and_b32 v6, 1, v1
    v_lshl_or_b32 v20, v6, 3, v20
    v_xor_b32 v21, 64, v20
    v_xor_b32 v22, 32, v20
    v_xor_b32 v23, 0x60, v20
    s_barrier
    s_cmp_lt_u32 s44, 6
    s_cbranch_scc1 L_gt_34
    s_cmp_eq_u32 s44, 6
    s_cbranch_scc1 L_gt_34a
    v_mov_b32 v5, 157192
    ds_write_b64 v5, v[14:15]
    s_branch L_gt_34
L_gt_34a:
    v_lshrrev_b32 v5, 5, v1
    v_lshlrev_b32 v5, 2, v5
    v_add_u32 v5, 157184, v5
    ds_write_b32 v5, v12
L_gt_34:
    ds_read_b128 v[60:63], v16 offset:0
    ds_read_b128 v[64:67], v17 offset:0
    ds_read_b128 v[68:71], v18 offset:0
    ds_read_b128 v[72:75], v19 offset:0
    ds_read_b128 v[76:79], v16 offset:256
    ds_read_b128 v[80:83], v17 offset:256
    ds_read_b128 v[84:87], v18 offset:256
    ds_read_b128 v[88:91], v19 offset:256
    s_add_u32 s64, s62, 196608
    v_xor_b32 v8, 0, v7
    buffer_load_dwordx4 v[220:223], v8, s[20:23], s64 offen offset:0 nt
    s_waitcnt lgkmcnt(4)
    v_mfma_f32_16x16x32_bf16 v[32:35], v[60:63], v[156:159], 0
    v_mfma_f32_16x16x32_bf16 v[32:35], v[64:67], v[160:163], v[32:35]
    v_mfma_f32_16x16x32_bf16 v[32:35], v[68:71], v[164:167], v[32:35]
    v_mfma_f32_16x16x32_bf16 v[32:35], v[72:75], v[168:171], v[32:35]
    ds_read_b128 v[60:63], v16 offset:512
    ds_read_b128 v[64:67], v17 offset:512
    ds_read_b128 v[68:71], v18 offset:512
    ds_read_b128 v[72:75], v19 offset:512
    s_waitcnt lgkmcnt(4)
    v_mfma_f32_16x16x32_bf16 v[32:35], v[76:79], v[172:175], v[32:35]
    v_mfma_f32_16x16x32_bf16 v[32:35], v[80:83], v[176:179], v[32:35]
    v_mfma_f32_16x16x32_bf16 v[32:35], v[84:87], v[180:183], v[32:35]
    v_mfma_f32_16x16x32_bf16 v[32:35], v[88:91], v[184:187], v[32:35]
    ds_read_b128 v[76:79], v16 offset:768
    ds_read_b128 v[80:83], v17 offset:768
    ds_read_b128 v[84:87], v18 offset:768
    ds_read_b128 v[88:91], v19 offset:768
    v_xor_b32 v8, 64, v7
    buffer_load_dwordx4 v[224:227], v8, s[20:23], s64 offen offset:1024 nt
    s_waitcnt lgkmcnt(4)
    v_mfma_f32_16x16x32_bf16 v[32:35], v[60:63], v[188:191], v[32:35]
    v_mfma_f32_16x16x32_bf16 v[32:35], v[64:67], v[192:195], v[32:35]
    v_mfma_f32_16x16x32_bf16 v[32:35], v[68:71], v[196:199], v[32:35]
    v_mfma_f32_16x16x32_bf16 v[32:35], v[72:75], v[200:203], v[32:35]
    v_xor_b32 v16, 0x10000, v16
    v_xor_b32 v17, 0x10000, v17
    v_xor_b32 v18, 0x10000, v18
    v_xor_b32 v19, 0x10000, v19
    ds_read_b128 v[60:63], v16 offset:0
    ds_read_b128 v[64:67], v17 offset:0
    ds_read_b128 v[68:71], v18 offset:0
    ds_read_b128 v[72:75], v19 offset:0
    s_waitcnt lgkmcnt(4)
    v_mfma_f32_16x16x32_bf16 v[32:35], v[76:79], v[204:207], v[32:35]
    v_mfma_f32_16x16x32_bf16 v[32:35], v[80:83], v[208:211], v[32:35]
    v_mfma_f32_16x16x32_bf16 v[32:35], v[84:87], v[212:215], v[32:35]
    v_mfma_f32_16x16x32_bf16 v[32:35], v[88:91], v[216:219], v[32:35]
    ds_read_b128 v[76:79], v16 offset:256
    ds_read_b128 v[80:83], v17 offset:256
    ds_read_b128 v[84:87], v18 offset:256
    ds_read_b128 v[88:91], v19 offset:256
    v_xor_b32 v8, 128, v7
    buffer_load_dwordx4 v[228:231], v8, s[20:23], s64 offen offset:2048 nt
    s_waitcnt lgkmcnt(4)
    v_mfma_f32_16x16x32_bf16 v[36:39], v[60:63], v[156:159], 0
    v_mfma_f32_16x16x32_bf16 v[36:39], v[64:67], v[160:163], v[36:39]
    v_mfma_f32_16x16x32_bf16 v[36:39], v[68:71], v[164:167], v[36:39]
    v_mfma_f32_16x16x32_bf16 v[36:39], v[72:75], v[168:171], v[36:39]
    ds_read_b128 v[60:63], v16 offset:512
    ds_read_b128 v[64:67], v17 offset:512
    ds_read_b128 v[68:71], v18 offset:512
    ds_read_b128 v[72:75], v19 offset:512
    s_waitcnt lgkmcnt(4)
    v_mfma_f32_16x16x32_bf16 v[36:39], v[76:79], v[172:175], v[36:39]
    v_mfma_f32_16x16x32_bf16 v[36:39], v[80:83], v[176:179], v[36:39]
    v_mfma_f32_16x16x32_bf16 v[36:39], v[84:87], v[180:183], v[36:39]
    v_mfma_f32_16x16x32_bf16 v[36:39], v[88:91], v[184:187], v[36:39]
    ds_read_b128 v[76:79], v16 offset:768
    ds_read_b128 v[80:83], v17 offset:768
    ds_read_b128 v[84:87], v18 offset:768
    ds_read_b128 v[88:91], v19 offset:768
    v_xor_b32 v16, 0x10000, v16
    v_xor_b32 v17, 0x10000, v17
    v_xor_b32 v18, 0x10000, v18
    v_xor_b32 v19, 0x10000, v19
    v_xor_b32 v8, 192, v7
    buffer_load_dwordx4 v[232:235], v8, s[20:23], s64 offen offset:3072 nt
    s_waitcnt lgkmcnt(4)
    v_mfma_f32_16x16x32_bf16 v[36:39], v[60:63], v[188:191], v[36:39]
    v_mfma_f32_16x16x32_bf16 v[36:39], v[64:67], v[192:195], v[36:39]
    v_mfma_f32_16x16x32_bf16 v[36:39], v[68:71], v[196:199], v[36:39]
    v_mfma_f32_16x16x32_bf16 v[36:39], v[72:75], v[200:203], v[36:39]
    s_waitcnt lgkmcnt(0)
    v_mfma_f32_16x16x32_bf16 v[36:39], v[76:79], v[204:207], v[36:39]
    v_mfma_f32_16x16x32_bf16 v[36:39], v[80:83], v[208:211], v[36:39]
    v_mfma_f32_16x16x32_bf16 v[36:39], v[84:87], v[212:215], v[36:39]
    v_mfma_f32_16x16x32_bf16 v[36:39], v[88:91], v[216:219], v[36:39]
    v_max3_f32 v5, v32, v33, v34
    s_nop 6
    v_max3_f32 v5, v5, v35, v36
    v_max3_f32 v5, v5, v37, v38
    v_max_f32 v5, v5, v39
    v_mov_b32 v6, v5
    s_nop 1
    v_permlane32_swap_b32 v6, v5
    v_max_f32 v5, v6, v5
    v_mov_b32 v6, v5
    s_nop 1
    v_permlane16_swap_b32 v6, v5
    v_max_f32 v5, v6, v5
    ds_write_b32 v9, v5
    s_waitcnt lgkmcnt(0)
    s_barrier
    v_mov_b32 v5, 157184
    ds_read_b128 v[12:15], v5
    ds_read_b128 v[40:43], v10
    ds_read_b128 v[252:255], v11
    s_add_u32 s64, s62, 229376
    v_xor_b32 v8, 0, v7
    buffer_load_dwordx4 v[236:239], v8, s[20:23], s64 offen offset:0 nt
    s_waitcnt lgkmcnt(1)
    v_max3_f32 v5, v40, v41, v42
    v_max_f32 v24, v5, v43
    v_readfirstlane_b32 s19, v15
    v_mul_f32 v29, s47, v24
    v_fma_f32 v32, v32, s47, -v29
    v_fma_f32 v33, v33, s47, -v29
    v_fma_f32 v34, v34, s47, -v29
    v_fma_f32 v35, v35, s47, -v29
    v_fma_f32 v36, v36, s47, -v29
    v_fma_f32 v37, v37, s47, -v29
    v_fma_f32 v38, v38, s47, -v29
    v_fma_f32 v39, v39, s47, -v29
    v_exp_f32 v32, v32
    v_exp_f32 v33, v33
    v_exp_f32 v34, v34
    v_exp_f32 v35, v35
    v_exp_f32 v36, v36
    v_exp_f32 v37, v37
    v_exp_f32 v38, v38
    v_exp_f32 v39, v39
    v_cvt_pk_bf16_f32 v40, v32, v33
    v_cvt_pk_bf16_f32 v41, v34, v35
    v_cvt_pk_bf16_f32 v42, v36, v37
    v_cvt_pk_bf16_f32 v43, v38, v39
    ds_write_b64 v30, v[40:41]
    ds_write_b64 v30, v[42:43] offset:128
    v_add_f32 v32, v32, v36
    v_add_f32 v33, v33, v37
    v_add_f32 v34, v34, v38
    v_add_f32 v35, v35, v39
    v_add_f32 v32, v32, v33
    v_add_f32 v34, v34, v35
    s_waitcnt lgkmcnt(2)
    v_max3_f32 v5, v252, v253, v254
    v_add_f32 v25, v32, v34
    v_max_f32 v26, v5, v255
    s_waitcnt lgkmcnt(0)
    s_barrier
    ds_read_b128 v[44:47], v31 offset:0
    ds_read_b64_tr_b16 v[60:61], v20 offset:0
    ds_read_b64_tr_b16 v[62:63], v22 offset:4096
    ds_read_b64_tr_b16 v[64:65], v21 offset:0
    ds_read_b64_tr_b16 v[66:67], v23 offset:4096
    ds_read_b128 v[48:51], v31 offset:32
    ds_read_b64_tr_b16 v[68:69], v20 offset:16384
    ds_read_b64_tr_b16 v[70:71], v22 offset:20480
    ds_read_b64_tr_b16 v[72:73], v21 offset:16384
    ds_read_b64_tr_b16 v[74:75], v23 offset:20480
    ds_read_b128 v[52:55], v31 offset:64
    ds_read_b64_tr_b16 v[76:77], v20 offset:32768
    ds_read_b64_tr_b16 v[78:79], v22 offset:36864
    ds_read_b64_tr_b16 v[80:81], v21 offset:32768
    ds_read_b64_tr_b16 v[82:83], v23 offset:36864
    ds_read_b128 v[56:59], v31 offset:96
    ds_read_b64_tr_b16 v[84:85], v20 offset:49152
    ds_read_b64_tr_b16 v[86:87], v22 offset:53248
    ds_read_b64_tr_b16 v[88:89], v21 offset:49152
    ds_read_b64_tr_b16 v[90:91], v23 offset:53248
    v_xor_b32 v8, 64, v7
    buffer_load_dwordx4 v[240:243], v8, s[20:23], s64 offen offset:1024 nt
    s_waitcnt lgkmcnt(15)
    v_mfma_f32_32x32x16_bf16 v[92:107], v[60:63], v[44:47], 0
    v_mfma_f32_32x32x16_bf16 v[108:123], v[64:67], v[44:47], 0
    v_xor_b32 v20, 0x10000, v20
    v_xor_b32 v21, 0x10000, v21
    v_xor_b32 v22, 0x10000, v22
    v_xor_b32 v23, 0x10000, v23
    ds_read_b128 v[44:47], v31 offset:128
    ds_read_b64_tr_b16 v[60:61], v20 offset:0
    ds_read_b64_tr_b16 v[62:63], v22 offset:4096
    ds_read_b64_tr_b16 v[64:65], v21 offset:0
    ds_read_b64_tr_b16 v[66:67], v23 offset:4096
    s_waitcnt lgkmcnt(15)
    v_mfma_f32_32x32x16_bf16 v[92:107], v[68:71], v[48:51], v[92:107]
    v_mfma_f32_32x32x16_bf16 v[108:123], v[72:75], v[48:51], v[108:123]
    ds_read_b128 v[48:51], v31 offset:160
    ds_read_b64_tr_b16 v[68:69], v20 offset:16384
    ds_read_b64_tr_b16 v[70:71], v22 offset:20480
    ds_read_b64_tr_b16 v[72:73], v21 offset:16384
    ds_read_b64_tr_b16 v[74:75], v23 offset:20480
    v_xor_b32 v8, 128, v7
    buffer_load_dwordx4 v[244:247], v8, s[20:23], s64 offen offset:2048 nt
    s_waitcnt lgkmcnt(15)
    v_mfma_f32_32x32x16_bf16 v[92:107], v[76:79], v[52:55], v[92:107]
    v_mfma_f32_32x32x16_bf16 v[108:123], v[80:83], v[52:55], v[108:123]
    ds_read_b128 v[52:55], v31 offset:192
    ds_read_b64_tr_b16 v[76:77], v20 offset:32768
    ds_read_b64_tr_b16 v[78:79], v22 offset:36864
    ds_read_b64_tr_b16 v[80:81], v21 offset:32768
    ds_read_b64_tr_b16 v[82:83], v23 offset:36864
    s_waitcnt lgkmcnt(15)
    v_mfma_f32_32x32x16_bf16 v[92:107], v[84:87], v[56:59], v[92:107]
    v_mfma_f32_32x32x16_bf16 v[108:123], v[88:91], v[56:59], v[108:123]
    ds_read_b128 v[56:59], v31 offset:224
    ds_read_b64_tr_b16 v[84:85], v20 offset:49152
    ds_read_b64_tr_b16 v[86:87], v22 offset:53248
    ds_read_b64_tr_b16 v[88:89], v21 offset:49152
    ds_read_b64_tr_b16 v[90:91], v23 offset:53248
    v_xor_b32 v20, 0x10000, v20
    v_xor_b32 v21, 0x10000, v21
    v_xor_b32 v22, 0x10000, v22
    v_xor_b32 v23, 0x10000, v23
    v_xor_b32 v8, 192, v7
    buffer_load_dwordx4 v[248:251], v8, s[20:23], s64 offen offset:3072 nt
    s_waitcnt lgkmcnt(15)
    v_mfma_f32_32x32x16_bf16 v[92:107], v[60:63], v[44:47], v[92:107]
    v_mfma_f32_32x32x16_bf16 v[108:123], v[64:67], v[44:47], v[108:123]
    s_waitcnt lgkmcnt(10)
    v_mfma_f32_32x32x16_bf16 v[92:107], v[68:71], v[48:51], v[92:107]
    v_mfma_f32_32x32x16_bf16 v[108:123], v[72:75], v[48:51], v[108:123]
    s_waitcnt lgkmcnt(5)
    v_mfma_f32_32x32x16_bf16 v[92:107], v[76:79], v[52:55], v[92:107]
    v_mfma_f32_32x32x16_bf16 v[108:123], v[80:83], v[52:55], v[108:123]
    s_waitcnt lgkmcnt(0)
    v_mfma_f32_32x32x16_bf16 v[92:107], v[84:87], v[56:59], v[92:107]
    v_mfma_f32_32x32x16_bf16 v[108:123], v[88:91], v[56:59], v[108:123]
    s_barrier
    s_lshl_b32 s51, s44, 12
    v_add_u32 v5, s51, v4
    v_add_u32 v29, 65536, v5
    ds_write_b128 v5, v[124:127] offset:0
    ds_write_b128 v5, v[128:131] offset:1024
    ds_write_b128 v5, v[132:135] offset:2048
    ds_write_b128 v5, v[136:139] offset:3072
    ds_write_b128 v5, v[140:143] offset:32768
    ds_write_b128 v5, v[144:147] offset:33792
    ds_write_b128 v5, v[148:151] offset:34816
    ds_write_b128 v5, v[152:155] offset:35840
    s_waitcnt vmcnt(7)
    ds_write_b128 v29, v[220:223] offset:0
    s_waitcnt vmcnt(6)
    ds_write_b128 v29, v[224:227] offset:1024
    s_waitcnt vmcnt(5)
    ds_write_b128 v29, v[228:231] offset:2048
    s_waitcnt vmcnt(4)
    ds_write_b128 v29, v[232:235] offset:3072
    s_waitcnt vmcnt(3)
    ds_write_b128 v29, v[236:239] offset:32768
    s_waitcnt vmcnt(2)
    ds_write_b128 v29, v[240:243] offset:33792
    s_waitcnt vmcnt(1)
    ds_write_b128 v29, v[244:247] offset:34816
    s_waitcnt vmcnt(0)
    ds_write_b128 v29, v[248:251] offset:35840
    v_lshrrev_b32 v8, 3, v1
    v_lshlrev_b32 v8, 16, v8
    v_and_b32 v6, 7, v1
    v_lshl_add_u32 v8, v6, 4, v8
    s_lshl_b32 s64, s44, 19
    s_add_u32 s64, s64, s63
    s_lshl_b32 s52, s58, 7
    s_add_u32 s64, s64, s52
    s_waitcnt lgkmcnt(0)
    s_barrier
    ds_read_b128 v[60:63], v16 offset:0
    ds_read_b128 v[64:67], v17 offset:0
    ds_read_b128 v[68:71], v18 offset:0
    ds_read_b128 v[72:75], v19 offset:0
    ds_read_b128 v[76:79], v16 offset:256
    ds_read_b128 v[80:83], v17 offset:256
    ds_read_b128 v[84:87], v18 offset:256
    ds_read_b128 v[88:91], v19 offset:256
    buffer_load_dwordx4 v[124:127], v8, s[24:27], s64 offen nt
    s_add_u32 s64, s64, 8192
    s_waitcnt lgkmcnt(4)
    v_mfma_f32_16x16x32_bf16 v[32:35], v[60:63], v[156:159], 0
    v_mfma_f32_16x16x32_bf16 v[32:35], v[64:67], v[160:163], v[32:35]
    v_mfma_f32_16x16x32_bf16 v[32:35], v[68:71], v[164:167], v[32:35]
    v_mfma_f32_16x16x32_bf16 v[32:35], v[72:75], v[168:171], v[32:35]
    ds_read_b128 v[60:63], v16 offset:512
    ds_read_b128 v[64:67], v17 offset:512
    ds_read_b128 v[68:71], v18 offset:512
    ds_read_b128 v[72:75], v19 offset:512
    s_waitcnt lgkmcnt(4)
    v_mfma_f32_16x16x32_bf16 v[32:35], v[76:79], v[172:175], v[32:35]
    v_mfma_f32_16x16x32_bf16 v[32:35], v[80:83], v[176:179], v[32:35]
    v_mfma_f32_16x16x32_bf16 v[32:35], v[84:87], v[180:183], v[32:35]
    v_mfma_f32_16x16x32_bf16 v[32:35], v[88:91], v[184:187], v[32:35]
    ds_read_b128 v[76:79], v16 offset:768
    ds_read_b128 v[80:83], v17 offset:768
    ds_read_b128 v[84:87], v18 offset:768
    ds_read_b128 v[88:91], v19 offset:768
    buffer_load_dwordx4 v[128:131], v8, s[24:27], s64 offen nt
    s_add_u32 s64, s64, 8192
    s_waitcnt lgkmcnt(4)
    v_mfma_f32_16x16x32_bf16 v[32:35], v[60:63], v[188:191], v[32:35]
    v_mfma_f32_16x16x32_bf16 v[32:35], v[64:67], v[192:195], v[32:35]
    v_mfma_f32_16x16x32_bf16 v[32:35], v[68:71], v[196:199], v[32:35]
    v_mfma_f32_16x16x32_bf16 v[32:35], v[72:75], v[200:203], v[32:35]
    v_xor_b32 v16, 0x10000, v16
    v_xor_b32 v17, 0x10000, v17
    v_xor_b32 v18, 0x10000, v18
    v_xor_b32 v19, 0x10000, v19
    ds_read_b128 v[60:63], v16 offset:0
    ds_read_b128 v[64:67], v17 offset:0
    ds_read_b128 v[68:71], v18 offset:0
    ds_read_b128 v[72:75], v19 offset:0
    s_waitcnt lgkmcnt(4)
    v_mfma_f32_16x16x32_bf16 v[32:35], v[76:79], v[204:207], v[32:35]
    v_mfma_f32_16x16x32_bf16 v[32:35], v[80:83], v[208:211], v[32:35]
    v_mfma_f32_16x16x32_bf16 v[32:35], v[84:87], v[212:215], v[32:35]
    v_mfma_f32_16x16x32_bf16 v[32:35], v[88:91], v[216:219], v[32:35]
    ds_read_b128 v[76:79], v16 offset:256
    ds_read_b128 v[80:83], v17 offset:256
    ds_read_b128 v[84:87], v18 offset:256
    ds_read_b128 v[88:91], v19 offset:256
    buffer_load_dwordx4 v[132:135], v8, s[24:27], s64 offen nt
    s_add_u32 s64, s64, 8192
    s_waitcnt lgkmcnt(4)
    v_mfma_f32_16x16x32_bf16 v[36:39], v[60:63], v[156:159], 0
    v_mfma_f32_16x16x32_bf16 v[36:39], v[64:67], v[160:163], v[36:39]
    v_mfma_f32_16x16x32_bf16 v[36:39], v[68:71], v[164:167], v[36:39]
    v_mfma_f32_16x16x32_bf16 v[36:39], v[72:75], v[168:171], v[36:39]
    ds_read_b128 v[60:63], v16 offset:512
    ds_read_b128 v[64:67], v17 offset:512
    ds_read_b128 v[68:71], v18 offset:512
    ds_read_b128 v[72:75], v19 offset:512
    s_waitcnt lgkmcnt(4)
    v_mfma_f32_16x16x32_bf16 v[36:39], v[76:79], v[172:175], v[36:39]
    v_mfma_f32_16x16x32_bf16 v[36:39], v[80:83], v[176:179], v[36:39]
    v_mfma_f32_16x16x32_bf16 v[36:39], v[84:87], v[180:183], v[36:39]
    v_mfma_f32_16x16x32_bf16 v[36:39], v[88:91], v[184:187], v[36:39]
    ds_read_b128 v[76:79], v16 offset:768
    ds_read_b128 v[80:83], v17 offset:768
    ds_read_b128 v[84:87], v18 offset:768
    ds_read_b128 v[88:91], v19 offset:768
    v_xor_b32 v16, 0x10000, v16
    v_xor_b32 v17, 0x10000, v17
    v_xor_b32 v18, 0x10000, v18
    v_xor_b32 v19, 0x10000, v19
    buffer_load_dwordx4 v[136:139], v8, s[24:27], s64 offen nt
    s_add_u32 s64, s64, 8192
    s_waitcnt lgkmcnt(4)
    v_mfma_f32_16x16x32_bf16 v[36:39], v[60:63], v[188:191], v[36:39]
    v_mfma_f32_16x16x32_bf16 v[36:39], v[64:67], v[192:195], v[36:39]
    v_mfma_f32_16x16x32_bf16 v[36:39], v[68:71], v[196:199], v[36:39]
    v_mfma_f32_16x16x32_bf16 v[36:39], v[72:75], v[200:203], v[36:39]
    s_waitcnt lgkmcnt(0)
    v_mfma_f32_16x16x32_bf16 v[36:39], v[76:79], v[204:207], v[36:39]
    v_mfma_f32_16x16x32_bf16 v[36:39], v[80:83], v[208:211], v[36:39]
    v_mfma_f32_16x16x32_bf16 v[36:39], v[84:87], v[212:215], v[36:39]
    v_mfma_f32_16x16x32_bf16 v[36:39], v[88:91], v[216:219], v[36:39]
    v_max3_f32 v5, v32, v33, v34
    s_nop 6
    v_max3_f32 v5, v5, v35, v36
    v_max3_f32 v5, v5, v37, v38
    v_max_f32 v5, v5, v39
    v_mov_b32 v6, v5
    s_nop 1
    v_permlane32_swap_b32 v6, v5
    v_max_f32 v5, v6, v5
    v_mov_b32 v6, v5
    s_nop 1
    v_permlane16_swap_b32 v6, v5
    v_max_f32 v5, v6, v5
    ds_write_b32 v9, v5
    s_waitcnt lgkmcnt(0)
    s_barrier
    ds_read_b128 v[40:43], v10
    ds_read_b128 v[252:255], v11
    buffer_load_dwordx4 v[140:143], v8, s[24:27], s64 offen nt
    s_add_u32 s64, s64, 8192
    s_waitcnt lgkmcnt(1)
    v_max3_f32 v5, v40, v41, v42
    v_max3_f32 v5, v5, v43, v24
    v_mul_f32 v29, s47, v5
    v_fma_f32 v27, v24, s47, -v29
    v_exp_f32 v27, v27
    v_fma_f32 v32, v32, s47, -v29
    v_fma_f32 v33, v33, s47, -v29
    v_fma_f32 v34, v34, s47, -v29
    v_fma_f32 v35, v35, s47, -v29
    v_fma_f32 v36, v36, s47, -v29
    v_fma_f32 v37, v37, s47, -v29
    v_fma_f32 v38, v38, s47, -v29
    v_fma_f32 v39, v39, s47, -v29
    v_exp_f32 v32, v32
    v_exp_f32 v33, v33
    v_exp_f32 v34, v34
    v_exp_f32 v35, v35
    v_exp_f32 v36, v36
    v_exp_f32 v37, v37
    v_exp_f32 v38, v38
    v_exp_f32 v39, v39
    v_cvt_pk_bf16_f32 v40, v32, v33
    v_cvt_pk_bf16_f32 v41, v34, v35
    v_cvt_pk_bf16_f32 v42, v36, v37
    v_cvt_pk_bf16_f32 v43, v38, v39
    ds_write_b64 v30, v[40:41]
    ds_write_b64 v30, v[42:43] offset:128
    v_add_f32 v32, v32, v36
    v_add_f32 v33, v33, v37
    v_add_f32 v34, v34, v38
    v_add_f32 v35, v35, v39
    v_add_f32 v32, v32, v33
    v_add_f32 v34, v34, v35
    s_waitcnt lgkmcnt(2)
    v_max3_f32 v5, v252, v253, v254
    v_add_f32 v32, v32, v34
    v_max3_f32 v5, v5, v255, v26
    v_fma_f32 v25, v25, v27, v32
    v_sub_f32 v28, v26, v5
    v_mul_f32 v28, s47, v28
    v_exp_f32 v28, v28
    v_mov_b32 v26, v5
    v_mov_b32 v6, v25
    s_nop 1
    v_permlane32_swap_b32 v6, v25
    v_add_f32 v25, v6, v25
    v_mov_b32 v6, v25
    s_nop 1
    v_permlane16_swap_b32 v6, v25
    v_add_f32 v25, v6, v25
    ds_write_b32 v9, v25 offset:512
    v_mul_f32 v92, v28, v92
    v_mul_f32 v93, v28, v93
    v_mul_f32 v94, v28, v94
    v_mul_f32 v95, v28, v95
    v_mul_f32 v96, v28, v96
    v_mul_f32 v97, v28, v97
    v_mul_f32 v98, v28, v98
    v_mul_f32 v99, v28, v99
    v_mul_f32 v100, v28, v100
    v_mul_f32 v101, v28, v101
    v_mul_f32 v102, v28, v102
    v_mul_f32 v103, v28, v103
    v_mul_f32 v104, v28, v104
    v_mul_f32 v105, v28, v105
    v_mul_f32 v106, v28, v106
    v_mul_f32 v107, v28, v107
    v_mul_f32 v108, v28, v108
    v_mul_f32 v109, v28, v109
    v_mul_f32 v110, v28, v110
    v_mul_f32 v111, v28, v111
    v_mul_f32 v112, v28, v112
    v_mul_f32 v113, v28, v113
    v_mul_f32 v114, v28, v114
    v_mul_f32 v115, v28, v115
    v_mul_f32 v116, v28, v116
    v_mul_f32 v117, v28, v117
    v_mul_f32 v118, v28, v118
    v_mul_f32 v119, v28, v119
    v_mul_f32 v120, v28, v120
    v_mul_f32 v121, v28, v121
    v_mul_f32 v122, v28, v122
    v_mul_f32 v123, v28, v123
    s_waitcnt lgkmcnt(0)
    s_barrier
    ds_read_b128 v[44:47], v31 offset:0
    ds_read_b64_tr_b16 v[60:61], v20 offset:0
    ds_read_b64_tr_b16 v[62:63], v22 offset:4096
    ds_read_b64_tr_b16 v[64:65], v21 offset:0
    ds_read_b64_tr_b16 v[66:67], v23 offset:4096
    ds_read_b128 v[48:51], v31 offset:32
    ds_read_b64_tr_b16 v[68:69], v20 offset:16384
    ds_read_b64_tr_b16 v[70:71], v22 offset:20480
    ds_read_b64_tr_b16 v[72:73], v21 offset:16384
    ds_read_b64_tr_b16 v[74:75], v23 offset:20480
    ds_read_b128 v[52:55], v31 offset:64
    ds_read_b64_tr_b16 v[76:77], v20 offset:32768
    ds_read_b64_tr_b16 v[78:79], v22 offset:36864
    ds_read_b64_tr_b16 v[80:81], v21 offset:32768
    ds_read_b64_tr_b16 v[82:83], v23 offset:36864
    ds_read_b128 v[56:59], v31 offset:96
    ds_read_b64_tr_b16 v[84:85], v20 offset:49152
    ds_read_b64_tr_b16 v[86:87], v22 offset:53248
    ds_read_b64_tr_b16 v[88:89], v21 offset:49152
    ds_read_b64_tr_b16 v[90:91], v23 offset:53248
    buffer_load_dwordx4 v[144:147], v8, s[24:27], s64 offen nt
    s_add_u32 s64, s64, 8192
    s_waitcnt lgkmcnt(15)
    v_mfma_f32_32x32x16_bf16 v[92:107], v[60:63], v[44:47], v[92:107]
    v_mfma_f32_32x32x16_bf16 v[108:123], v[64:67], v[44:47], v[108:123]
    v_xor_b32 v20, 0x10000, v20
    v_xor_b32 v21, 0x10000, v21
    v_xor_b32 v22, 0x10000, v22
    v_xor_b32 v23, 0x10000, v23
    ds_read_b128 v[44:47], v31 offset:128
    ds_read_b64_tr_b16 v[60:61], v20 offset:0
    ds_read_b64_tr_b16 v[62:63], v22 offset:4096
    ds_read_b64_tr_b16 v[64:65], v21 offset:0
    ds_read_b64_tr_b16 v[66:67], v23 offset:4096
    s_waitcnt lgkmcnt(15)
    v_mfma_f32_32x32x16_bf16 v[92:107], v[68:71], v[48:51], v[92:107]
    v_mfma_f32_32x32x16_bf16 v[108:123], v[72:75], v[48:51], v[108:123]
    ds_read_b128 v[48:51], v31 offset:160
    ds_read_b64_tr_b16 v[68:69], v20 offset:16384
    ds_read_b64_tr_b16 v[70:71], v22 offset:20480
    ds_read_b64_tr_b16 v[72:73], v21 offset:16384
    ds_read_b64_tr_b16 v[74:75], v23 offset:20480
    buffer_load_dwordx4 v[148:151], v8, s[24:27], s64 offen nt
    s_add_u32 s64, s64, 8192
    s_waitcnt lgkmcnt(15)
    v_mfma_f32_32x32x16_bf16 v[92:107], v[76:79], v[52:55], v[92:107]
    v_mfma_f32_32x32x16_bf16 v[108:123], v[80:83], v[52:55], v[108:123]
    ds_read_b128 v[52:55], v31 offset:192
    ds_read_b64_tr_b16 v[76:77], v20 offset:32768
    ds_read_b64_tr_b16 v[78:79], v22 offset:36864
    ds_read_b64_tr_b16 v[80:81], v21 offset:32768
    ds_read_b64_tr_b16 v[82:83], v23 offset:36864
    s_waitcnt lgkmcnt(15)
    v_mfma_f32_32x32x16_bf16 v[92:107], v[84:87], v[56:59], v[92:107]
    v_mfma_f32_32x32x16_bf16 v[108:123], v[88:91], v[56:59], v[108:123]
    ds_read_b128 v[56:59], v31 offset:224
    ds_read_b64_tr_b16 v[84:85], v20 offset:49152
    ds_read_b64_tr_b16 v[86:87], v22 offset:53248
    ds_read_b64_tr_b16 v[88:89], v21 offset:49152
    ds_read_b64_tr_b16 v[90:91], v23 offset:53248
    v_xor_b32 v20, 0x10000, v20
    v_xor_b32 v21, 0x10000, v21
    v_xor_b32 v22, 0x10000, v22
    v_xor_b32 v23, 0x10000, v23
    buffer_load_dwordx4 v[152:155], v8, s[24:27], s64 offen nt
    s_waitcnt lgkmcnt(15)
    v_mfma_f32_32x32x16_bf16 v[92:107], v[60:63], v[44:47], v[92:107]
    v_mfma_f32_32x32x16_bf16 v[108:123], v[64:67], v[44:47], v[108:123]
    s_waitcnt lgkmcnt(10)
    v_mfma_f32_32x32x16_bf16 v[92:107], v[68:71], v[48:51], v[92:107]
    v_mfma_f32_32x32x16_bf16 v[108:123], v[72:75], v[48:51], v[108:123]
    s_waitcnt lgkmcnt(5)
    v_mfma_f32_32x32x16_bf16 v[92:107], v[76:79], v[52:55], v[92:107]
    v_mfma_f32_32x32x16_bf16 v[108:123], v[80:83], v[52:55], v[108:123]
    s_waitcnt lgkmcnt(0)
    v_mfma_f32_32x32x16_bf16 v[92:107], v[84:87], v[56:59], v[92:107]
    v_mfma_f32_32x32x16_bf16 v[108:123], v[88:91], v[56:59], v[108:123]
    s_barrier
    ds_read_b128 v[40:43], v11 offset:512
    v_and_b32 v5, 31, v1
    v_mul_u32_u24 v5, 1040, v5
    v_lshrrev_b32 v6, 5, v1
    v_lshl_add_u32 v5, v6, 3, v5
    s_lshl_b32 s51, s44, 7
    s_add_u32 s51, s51, 98304
    v_add_u32 v5, s51, v5
    s_waitcnt lgkmcnt(0)
    v_add_f32 v40, v40, v41
    v_add_f32 v42, v42, v43
    v_add_f32 v40, v40, v42
    v_rcp_f32 v28, v40
    v_log_f32 v40, v40
    v_mov_b32 v41, v14
    v_fma_f32 v40, v26, s47, v40
    v_mul_f32 v92, v28, v92
    v_mul_f32 v93, v28, v93
    v_mul_f32 v94, v28, v94
    v_mul_f32 v95, v28, v95
    v_mul_f32 v96, v28, v96
    v_mul_f32 v97, v28, v97
    v_mul_f32 v98, v28, v98
    v_mul_f32 v99, v28, v99
    v_mul_f32 v100, v28, v100
    v_mul_f32 v101, v28, v101
    v_mul_f32 v102, v28, v102
    v_mul_f32 v103, v28, v103
    v_mul_f32 v104, v28, v104
    v_mul_f32 v105, v28, v105
    v_mul_f32 v106, v28, v106
    v_mul_f32 v107, v28, v107
    v_mul_f32 v108, v28, v108
    v_mul_f32 v109, v28, v109
    v_mul_f32 v110, v28, v110
    v_mul_f32 v111, v28, v111
    v_mul_f32 v112, v28, v112
    v_mul_f32 v113, v28, v113
    v_mul_f32 v114, v28, v114
    v_mul_f32 v115, v28, v115
    v_mul_f32 v116, v28, v116
    v_mul_f32 v117, v28, v117
    v_mul_f32 v118, v28, v118
    v_mul_f32 v119, v28, v119
    v_mul_f32 v120, v28, v120
    v_mul_f32 v121, v28, v121
    v_mul_f32 v122, v28, v122
    v_mul_f32 v123, v28, v123
    v_cvt_pk_bf16_f32 v60, v92, v93
    v_cvt_pk_bf16_f32 v61, v94, v95
    v_cvt_pk_bf16_f32 v62, v96, v97
    v_cvt_pk_bf16_f32 v63, v98, v99
    v_cvt_pk_bf16_f32 v64, v100, v101
    v_cvt_pk_bf16_f32 v65, v102, v103
    v_cvt_pk_bf16_f32 v66, v104, v105
    v_cvt_pk_bf16_f32 v67, v106, v107
    v_cvt_pk_bf16_f32 v68, v108, v109
    v_cvt_pk_bf16_f32 v69, v110, v111
    v_cvt_pk_bf16_f32 v70, v112, v113
    v_cvt_pk_bf16_f32 v71, v114, v115
    v_cvt_pk_bf16_f32 v72, v116, v117
    v_cvt_pk_bf16_f32 v73, v118, v119
    v_cvt_pk_bf16_f32 v74, v120, v121
    v_cvt_pk_bf16_f32 v75, v122, v123
    ds_write_b64 v5, v[60:61] offset:0
    ds_write_b64 v5, v[62:63] offset:16
    ds_write_b64 v5, v[64:65] offset:32
    ds_write_b64 v5, v[66:67] offset:48
    ds_write_b64 v5, v[68:69] offset:64
    ds_write_b64 v5, v[70:71] offset:80
    ds_write_b64 v5, v[72:73] offset:96
    ds_write_b64 v5, v[74:75] offset:112
    s_mul_i32 s51, s44, 4160
    s_add_u32 s51, s51, 98304
    v_add_u32 v5, s51, v4
    s_lshl_b32 s49, s16, 18
    s_lshl_b32 s50, s44, 15
    s_add_u32 s49, s49, s50
    s_lshl_b32 s50, s17, 10
    s_add_u32 s49, s49, s50
    s_add_u32 s49, s49, 2097152
    s_mul_i32 s65, s59, 73728
    s_mul_i32 s66, s44, 9216
    s_add_u32 s65, s65, s66
    s_mul_i32 s67, s44, 72
    v_lshrrev_b32 v24, 3, v1
    v_add_u32 v24, s67, v24
    v_mul_u32_u24 v24, 7282, v24
    s_waitcnt lgkmcnt(0)
    s_barrier
    ds_read_b128 v[60:63], v5 offset:0
    ds_read_b128 v[64:67], v5 offset:1040
    ds_read_b128 v[68:71], v5 offset:2080
    ds_read_b128 v[72:75], v5 offset:3120
    v_and_b32 v6, 31, v1
    v_lshlrev_b32 v5, 6, v6
    v_lshlrev_b32 v9, 3, v6
    s_lshl_b32 s53, s16, 11
    s_add_u32 s53, s53, 589824
    s_lshl_b32 s50, s17, 3
    s_add_u32 s50, s50, s53
    s_lshl_b32 s51, s17, 8
    s_add_u32 s53, s53, s51
    s_waitcnt lgkmcnt(0)
    s_cmp_lg_u32 s19, 0
    s_cbranch_scc1 L_fl_35
    buffer_store_dwordx4 v[60:63], v4, s[8:11], s49 offen sc1
    s_add_u32 s49, s49, 8192
    buffer_store_dwordx4 v[64:67], v4, s[8:11], s49 offen sc1
    s_add_u32 s49, s49, 8192
    buffer_store_dwordx4 v[68:71], v4, s[8:11], s49 offen sc1
    s_add_u32 s49, s49, 8192
    buffer_store_dwordx4 v[72:75], v4, s[8:11], s49 offen sc1
    s_branch L_fl_35d
L_fl_35:
    buffer_store_dwordx4 v[60:63], v4, s[8:11], s49 offen
    s_add_u32 s49, s49, 8192
    buffer_store_dwordx4 v[64:67], v4, s[8:11], s49 offen
    s_add_u32 s49, s49, 8192
    buffer_store_dwordx4 v[68:71], v4, s[8:11], s49 offen
    s_add_u32 s49, s49, 8192
    buffer_store_dwordx4 v[72:75], v4, s[8:11], s49 offen
L_fl_35d:
    s_waitcnt vmcnt(0)
    s_barrier
    s_cmp_lg_u32 s44, 7
    s_cbranch_scc1 L_n_36
    s_cmp_lg_u32 s19, 0
    s_cbranch_scc1 L_fl_37
    buffer_store_dwordx2 v[40:41], v5, s[8:11], s50 offen sc1
    s_branch L_fl_37d
L_fl_37:
    buffer_store_dwordx2 v[40:41], v5, s[8:11], s50 offen
L_fl_37d:
L_n_36:
    v_lshrrev_b32 v6, 5, v1
    v_and_b32 v5, 31, v1
    v_lshlrev_b32 v5, 4, v5
    v_lshl_add_u32 v10, v6, 10, v5
    v_lshl_add_u32 v11, v6, 3, v5
    s_lshr_b32 s50, s44, 1
    s_lshl_b32 s51, s17, 2
    s_add_u32 s51, s51, s50
    s_lshl_b32 s49, s16, 5
    s_add_u32 s49, s49, s51
    s_lshl_b32 s49, s49, 13
    s_and_b32 s52, s44, 1
    s_lshl_b32 s52, s52, 9
    s_add_u32 s49, s49, s52
    s_add_u32 s49, s49, 2097152
    s_add_u32 s56, s49, 4096
    s_mov_b32 s42, 0
    s_mov_b32 s48, 524288
    s_waitcnt vmcnt(3)
    s_add_u32 m0, s66, 0
    s_add_u32 s68, s65, 0
    v_add_u32 v27, 0, v24
    v_bfe_u32 v27, v27, 17, 2
    v_lshlrev_b32 v27, 5, v27
    v_xor_b32 v27, v27, v4
    buffer_load_dwordx4 v27, s[28:31], s68 offen offset:0 nt lds
    s_waitcnt vmcnt(3)
    v_add_u32 v27, 58256, v24
    v_bfe_u32 v27, v27, 17, 2
    v_lshlrev_b32 v27, 5, v27
    v_xor_b32 v27, v27, v4
    buffer_load_dwordx4 v27, s[28:31], s68 offen offset:1024 nt lds
    s_waitcnt vmcnt(3)
    v_add_u32 v27, 116512, v24
    v_bfe_u32 v27, v27, 17, 2
    v_lshlrev_b32 v27, 5, v27
    v_xor_b32 v27, v27, v4
    buffer_load_dwordx4 v27, s[28:31], s68 offen offset:2048 nt lds
    s_waitcnt vmcnt(3)
    v_add_u32 v27, 174768, v24
    v_bfe_u32 v27, v27, 17, 2
    v_lshlrev_b32 v27, 5, v27
    v_xor_b32 v27, v27, v4
    buffer_load_dwordx4 v27, s[28:31], s68 offen offset:3072 nt lds
    s_waitcnt vmcnt(3)
    s_add_u32 m0, s66, 4096
    s_add_u32 s68, s65, 4096
    v_add_u32 v27, 233024, v24
    v_bfe_u32 v27, v27, 17, 2
    v_lshlrev_b32 v27, 5, v27
    v_xor_b32 v27, v27, v4
    buffer_load_dwordx4 v27, s[28:31], s68 offen offset:0 nt lds
    s_waitcnt vmcnt(3)
    v_add_u32 v27, 291280, v24
    v_bfe_u32 v27, v27, 17, 2
    v_lshlrev_b32 v27, 5, v27
    v_xor_b32 v27, v27, v4
    buffer_load_dwordx4 v27, s[28:31], s68 offen offset:1024 nt lds
L_B_p1:
    buffer_load_dwordx2 v[32:33], v9, s[8:11], s53 offen sc1
    s_waitcnt vmcnt(0)
    v_cmp_ne_u32 vcc, v33, v14
    s_nop 1
    s_cbranch_vccz L_ok_38
    s_sub_u32 s48, s48, 1
    s_cbranch_scc1 L_end
    s_branch L_B_p1
L_ok_38:
    buffer_load_dwordx4 v[60:63], v10, s[8:11], s49 offen offset:0 sc1
    buffer_load_dwordx4 v[64:67], v10, s[8:11], s49 offen offset:2048 sc1
    buffer_load_dwordx4 v[68:71], v10, s[8:11], s56 offen offset:0 sc1
    buffer_load_dwordx4 v[72:75], v10, s[8:11], s56 offen offset:2048 sc1
    s_lshl_b32 s51, s51, 3
    s_lshl_b32 s49, s60, 2
    s_add_u32 s51, s51, s49
    s_add_u32 s51, s51, s61
    s_lshl_b32 s51, s51, 10
    s_add_u32 s51, s51, s52
    s_add_u32 s51, s51, 1310720
    s_lshl_b32 s50, s50, 5
    v_lshl_add_u32 v6, v6, 2, s50
    v_max_f32_dpp v5, v32, v32 quad_perm:[1,0,3,2] row_mask:0xf bank_mask:0xf
    s_nop 1
    v_max_f32_dpp v5, v5, v5 quad_perm:[2,3,0,1] row_mask:0xf bank_mask:0xf
    s_nop 1
    v_max_f32_dpp v5, v5, v5 row_half_mirror row_mask:0xf bank_mask:0xf
    v_sub_f32 v32, v32, v5
    v_exp_f32 v32, v32
    s_nop 1
    v_add_f32_dpp v40, v32, v32 quad_perm:[1,0,3,2] row_mask:0xf bank_mask:0xf
    s_nop 1
    v_add_f32_dpp v40, v40, v40 quad_perm:[2,3,0,1] row_mask:0xf bank_mask:0xf
    s_nop 1
    v_add_f32_dpp v40, v40, v40 row_half_mirror row_mask:0xf bank_mask:0xf
    v_rcp_f32 v28, v40
    v_log_f32 v40, v40
    v_mul_f32 v32, v32, v28
    v_add_f32 v40, v40, v5
    ds_bpermute_b32 v44, v6, v32 offset:0
    ds_bpermute_b32 v45, v6, v32 offset:8
    ds_bpermute_b32 v46, v6, v32 offset:16
    ds_bpermute_b32 v47, v6, v32 offset:24
    s_waitcnt vmcnt(0) lgkmcnt(0)
    v_lshlrev_b32 v252, 16, v60
    v_and_b32 v253, 0xffff0000, v60
    v_mul_f32 v92, v44, v252
    v_mul_f32 v93, v44, v253
    v_lshlrev_b32 v252, 16, v61
    v_and_b32 v253, 0xffff0000, v61
    v_mul_f32 v94, v44, v252
    v_mul_f32 v95, v44, v253
    v_lshlrev_b32 v252, 16, v62
    v_and_b32 v253, 0xffff0000, v62
    v_mul_f32 v96, v44, v252
    v_mul_f32 v97, v44, v253
    v_lshlrev_b32 v252, 16, v63
    v_and_b32 v253, 0xffff0000, v63
    v_mul_f32 v98, v44, v252
    v_mul_f32 v99, v44, v253
    v_lshlrev_b32 v252, 16, v64
    v_and_b32 v253, 0xffff0000, v64
    v_fmac_f32 v92, v45, v252
    v_fmac_f32 v93, v45, v253
    v_lshlrev_b32 v252, 16, v65
    v_and_b32 v253, 0xffff0000, v65
    v_fmac_f32 v94, v45, v252
    v_fmac_f32 v95, v45, v253
    v_lshlrev_b32 v252, 16, v66
    v_and_b32 v253, 0xffff0000, v66
    v_fmac_f32 v96, v45, v252
    v_fmac_f32 v97, v45, v253
    v_lshlrev_b32 v252, 16, v67
    v_and_b32 v253, 0xffff0000, v67
    v_fmac_f32 v98, v45, v252
    v_fmac_f32 v99, v45, v253
    v_lshlrev_b32 v252, 16, v68
    v_and_b32 v253, 0xffff0000, v68
    v_fmac_f32 v92, v46, v252
    v_fmac_f32 v93, v46, v253
    v_lshlrev_b32 v252, 16, v69
    v_and_b32 v253, 0xffff0000, v69
    v_fmac_f32 v94, v46, v252
    v_fmac_f32 v95, v46, v253
    v_lshlrev_b32 v252, 16, v70
    v_and_b32 v253, 0xffff0000, v70
    v_fmac_f32 v96, v46, v252
    v_fmac_f32 v97, v46, v253
    v_lshlrev_b32 v252, 16, v71
    v_and_b32 v253, 0xffff0000, v71
    v_fmac_f32 v98, v46, v252
    v_fmac_f32 v99, v46, v253
    v_lshlrev_b32 v252, 16, v72
    v_and_b32 v253, 0xffff0000, v72
    v_fmac_f32 v92, v47, v252
    v_fmac_f32 v93, v47, v253
    v_lshlrev_b32 v252, 16, v73
    v_and_b32 v253, 0xffff0000, v73
    v_fmac_f32 v94, v47, v252
    v_fmac_f32 v95, v47, v253
    v_lshlrev_b32 v252, 16, v74
    v_and_b32 v253, 0xffff0000, v74
    v_fmac_f32 v96, v47, v252
    v_fmac_f32 v97, v47, v253
    v_lshlrev_b32 v252, 16, v75
    v_and_b32 v253, 0xffff0000, v75
    v_fmac_f32 v98, v47, v252
    v_fmac_f32 v99, v47, v253
    v_permlane32_swap_b32 v92, v96
    v_permlane32_swap_b32 v93, v97
    v_permlane32_swap_b32 v94, v98
    v_permlane32_swap_b32 v95, v99
    v_add_f32 v92, v92, v96
    v_add_f32 v93, v93, v97
    v_add_f32 v94, v94, v98
    v_add_f32 v95, v95, v99
    v_cvt_pk_bf16_f32 v92, v92, v93
    v_cvt_pk_bf16_f32 v93, v94, v95
    buffer_store_dwordx2 v[92:93], v11, s[8:11], s51 offen sc1
    s_waitcnt vmcnt(0)
    v_lshlrev_b32 v5, 3, v1
    s_lshl_b32 s49, s17, 5
    s_lshl_b32 s50, s60, 2
    s_add_u32 s49, s49, s50
    s_add_u32 s49, s49, s61
    s_lshl_b32 s49, s49, 3
    s_add_u32 s49, s49, 606208
    s_barrier
    s_cmp_lg_u32 s44, 7
    s_cbranch_scc1 L_B_n2
    s_mov_b64 exec, 0x01010101
    buffer_store_dwordx2 v[40:41], v5, s[8:11], s49 offen sc1
    s_mov_b64 exec, -1
L_B_n2:
    v_and_b32 v9, 7, v1
    v_lshlrev_b32 v9, 3, v9
    s_lshl_b32 s49, s57, 6
    s_add_u32 s49, s49, 606208
    s_mov_b32 s48, 524288
L_B_p2:
    buffer_load_dwordx2 v[32:33], v9, s[8:11], s49 offen sc1
    s_waitcnt vmcnt(0)
    v_cmp_ne_u32 vcc, v33, v14
    s_nop 1
    s_cbranch_vccz L_ok_39
    s_sub_u32 s48, s48, 1
    s_cbranch_scc1 L_end
    s_sleep 1
    s_branch L_B_p2
L_ok_39:
    v_lshlrev_b32 v6, 4, v3
    v_lshl_or_b32 v5, v2, 10, v6
    s_lshr_b32 s50, s44, 2
    s_lshl_b32 s49, s57, 1
    s_add_u32 s49, s49, s50
    s_lshl_b32 s49, s49, 12
    s_and_b32 s51, s44, 3
    s_lshl_b32 s51, s51, 8
    s_add_u32 s49, s49, s51
    s_add_u32 s49, s49, 1310720
    buffer_load_dwordx4 v[60:63], v5, s[8:11], s49 offen sc1
    s_lshl_b32 s49, s50, 10
    s_add_u32 s49, s49, s51
    s_add_u32 s49, s49, 147456
    v_lshl_add_u32 v11, v2, 2, v6
    v_add_u32 v11, s49, v11
    s_lshl_b32 s50, s50, 4
    v_lshl_add_u32 v6, v2, 2, s50
    v_max_f32_dpp v5, v32, v32 quad_perm:[1,0,3,2] row_mask:0xf bank_mask:0xf
    s_nop 1
    v_max_f32_dpp v5, v5, v5 quad_perm:[2,3,0,1] row_mask:0xf bank_mask:0xf
    v_sub_f32 v32, v32, v5
    v_exp_f32 v32, v32
    s_nop 1
    v_add_f32_dpp v5, v32, v32 quad_perm:[1,0,3,2] row_mask:0xf bank_mask:0xf
    s_nop 1
    v_add_f32_dpp v5, v5, v5 quad_perm:[2,3,0,1] row_mask:0xf bank_mask:0xf
    v_rcp_f32 v5, v5
    s_nop 0
    v_mul_f32 v32, v32, v5
    ds_bpermute_b32 v44, v6, v32
    s_waitcnt vmcnt(0) lgkmcnt(0)
    v_lshlrev_b32 v252, 16, v60
    v_and_b32 v253, 0xffff0000, v60
    v_mul_f32 v92, v44, v252
    v_mul_f32 v93, v44, v253
    v_lshlrev_b32 v252, 16, v61
    v_and_b32 v253, 0xffff0000, v61
    v_mul_f32 v94, v44, v252
    v_mul_f32 v95, v44, v253
    v_lshlrev_b32 v252, 16, v62
    v_and_b32 v253, 0xffff0000, v62
    v_mul_f32 v96, v44, v252
    v_mul_f32 v97, v44, v253
    v_lshlrev_b32 v252, 16, v63
    v_and_b32 v253, 0xffff0000, v63
    v_mul_f32 v98, v44, v252
    v_mul_f32 v99, v44, v253
    v_permlane32_swap_b32 v92, v96
    v_permlane32_swap_b32 v93, v97
    v_permlane32_swap_b32 v94, v98
    v_permlane32_swap_b32 v95, v99
    v_add_f32 v92, v92, v96
    v_add_f32 v93, v93, v97
    v_add_f32 v94, v94, v98
    v_add_f32 v95, v95, v99
    s_nop 0
    v_permlane16_swap_b32 v92, v94
    v_permlane16_swap_b32 v93, v95
    v_add_f32 v92, v92, v94
    v_add_f32 v93, v93, v95
    v_cvt_pk_bf16_f32 v92, v92, v93
    ds_write_b32 v11, v92
    v_bfe_u32 v5, v1, 2, 1
    v_lshlrev_b32 v5, 10, v5
    v_lshl_add_u32 v5, v2, 5, v5
    v_bfe_u32 v6, v1, 3, 1
    v_lshl_add_u32 v5, v6, 4, v5
    s_lshl_b32 s49, s44, 7
    s_add_u32 s49, s49, 147456
    v_add_u32 v5, s49, v5
    v_lshrrev_b32 v10, 5, v1
    v_cmp_eq_u32 vcc, v10, v6
    v_lshlrev_b32 v10, 8, v2
    v_and_b32 v6, 7, v1
    v_lshl_add_u32 v10, v6, 5, v10
    s_lshl_b32 s49, s44, 10
    v_add_u32 v10, s49, v10
    v_mov_b32 v6, 8192
    v_cndmask_b32 v10, v6, v10, vcc
    v_add_u32 v10, 149504, v10
    s_waitcnt lgkmcnt(0)
    s_barrier
    ds_read_b128 v[44:47], v5
    s_waitcnt lgkmcnt(0)
    v_perm_b32 v40, v128, v124, s45
    v_perm_b32 v41, v136, v132, s45
    v_perm_b32 v42, v144, v140, s45
    v_perm_b32 v43, v152, v148, s45
    v_perm_b32 v252, v128, v124, s46
    v_perm_b32 v253, v136, v132, s46
    v_perm_b32 v254, v144, v140, s46
    v_perm_b32 v255, v152, v148, s46
    v_mfma_f32_16x16x32_bf16 v[92:95], v[44:47], v[40:43], 0
    v_perm_b32 v40, v129, v125, s45
    v_perm_b32 v41, v137, v133, s45
    v_perm_b32 v42, v145, v141, s45
    v_perm_b32 v43, v153, v149, s45
    v_mfma_f32_16x16x32_bf16 v[96:99], v[44:47], v[252:255], 0
    v_perm_b32 v252, v129, v125, s46
    v_perm_b32 v253, v137, v133, s46
    v_perm_b32 v254, v145, v141, s46
    v_perm_b32 v255, v153, v149, s46
    v_mfma_f32_16x16x32_bf16 v[100:103], v[44:47], v[40:43], 0
    v_perm_b32 v40, v130, v126, s45
    v_perm_b32 v41, v138, v134, s45
    v_perm_b32 v42, v146, v142, s45
    v_perm_b32 v43, v154, v150, s45
    v_mfma_f32_16x16x32_bf16 v[104:107], v[44:47], v[252:255], 0
    v_perm_b32 v252, v130, v126, s46
    v_perm_b32 v253, v138, v134, s46
    v_perm_b32 v254, v146, v142, s46
    v_perm_b32 v255, v154, v150, s46
    v_mfma_f32_16x16x32_bf16 v[108:111], v[44:47], v[40:43], 0
    v_perm_b32 v40, v131, v127, s45
    v_perm_b32 v41, v139, v135, s45
    v_perm_b32 v42, v147, v143, s45
    v_perm_b32 v43, v155, v151, s45
    v_mfma_f32_16x16x32_bf16 v[112:115], v[44:47], v[252:255], 0
    v_perm_b32 v252, v131, v127, s46
    v_perm_b32 v253, v139, v135, s46
    v_perm_b32 v254, v147, v143, s46
    v_perm_b32 v255, v155, v151, s46
    v_mfma_f32_16x16x32_bf16 v[116:119], v[44:47], v[40:43], 0
    s_nop 0
    v_mfma_f32_16x16x32_bf16 v[120:123], v[44:47], v[252:255], 0
    v_mov_b32 v44, v92
    v_mov_b32 v45, v96
    v_mov_b32 v46, v100
    v_mov_b32 v47, v104
    v_mov_b32 v48, v108
    v_mov_b32 v49, v112
    v_mov_b32 v50, v116
    s_nop 0
    v_mov_b32 v51, v120
    ds_write_b128 v10, v[44:47]
    ds_write_b128 v10, v[48:51] offset:16
    s_waitcnt lgkmcnt(0)
    s_barrier
    s_cmp_lg_u32 s44, 0
    s_cbranch_scc1 L_B_nx
    v_lshrrev_b32 v6, 5, v1
    v_and_b32 v5, 31, v1
    v_lshlrev_b32 v5, 4, v5
    v_lshl_add_u32 v5, v6, 12, v5
    v_add_u32 v5, 149504, v5
    ds_read_b128 v[60:63], v5 offset:0
    ds_read_b128 v[64:67], v5 offset:512
    ds_read_b128 v[68:71], v5 offset:1024
    ds_read_b128 v[72:75], v5 offset:1536
    ds_read_b128 v[76:79], v5 offset:2048
    ds_read_b128 v[80:83], v5 offset:2560
    ds_read_b128 v[84:87], v5 offset:3072
    ds_read_b128 v[88:91], v5 offset:3584
    v_bfe_u32 v6, v1, 4, 1
    v_cmp_eq_u32 vcc, 0, v6
    s_nop 1
    v_cndmask_b32 v32, v13, v12, vcc
    v_sub_f32 v32, 1.0, v32
    v_cvt_pk_bf16_f32 v32, v32, v32
    v_lshlrev_b32 v32, 16, v32
    v_cmp_gt_u32 vcc, 32, v1
    v_lshlrev_b32 v5, 3, v1
    v_add_u32 v5, 157952, v5
    s_waitcnt lgkmcnt(0)
    v_add_f32 v60, v60, v64
    v_add_f32 v68, v68, v72
    v_add_f32 v76, v76, v80
    v_add_f32 v84, v84, v88
    v_add_f32 v60, v60, v68
    v_add_f32 v76, v76, v84
    v_add_f32 v60, v60, v76
    v_add_f32 v61, v61, v65
    v_add_f32 v69, v69, v73
    v_add_f32 v77, v77, v81
    v_add_f32 v85, v85, v89
    v_add_f32 v61, v61, v69
    v_add_f32 v77, v77, v85
    v_add_f32 v61, v61, v77
    v_add_f32 v62, v62, v66
    v_add_f32 v70, v70, v74
    v_add_f32 v78, v78, v82
    v_add_f32 v86, v86, v90
    v_add_f32 v62, v62, v70
    v_add_f32 v78, v78, v86
    v_add_f32 v62, v62, v78
    v_add_f32 v63, v63, v67
    v_add_f32 v71, v71, v75
    v_add_f32 v79, v79, v83
    v_add_f32 v87, v87, v91
    v_add_f32 v63, v63, v71
    v_add_f32 v79, v79, v87
    v_add_f32 v63, v63, v79
    v_mov_b32 v6, v60
    s_nop 1
    v_permlane32_swap_b32 v6, v60
    v_add_f32 v60, v6, v60
    v_mov_b32 v6, v61
    s_nop 1
    v_permlane32_swap_b32 v6, v61
    v_add_f32 v61, v6, v61
    v_mov_b32 v6, v62
    s_nop 1
    v_permlane32_swap_b32 v6, v62
    v_add_f32 v62, v6, v62
    v_mov_b32 v6, v63
    s_nop 1
    v_permlane32_swap_b32 v6, v63
    v_add_f32 v63, v6, v63
    v_mul_f32 v60, v32, v60
    v_mul_f32 v61, v32, v61
    v_mul_f32 v62, v32, v62
    v_mul_f32 v63, v32, v63
    v_cvt_pk_bf16_f32 v60, v60, v61
    v_cvt_pk_bf16_f32 v61, v62, v63
    v_cndmask_b32 v60, 0, v60, vcc
    v_cndmask_b32 v61, 0, v61, vcc
    ds_write_b64 v5, v[60:61]
L_B_nx:
    s_waitcnt lgkmcnt(0)
    s_barrier
    s_cmp_ge_u32 s44, 6
    s_cbranch_scc1 L_B_red
    v_min_u32 v5, 2, v3
    v_lshlrev_b32 v5, 7, v5
    v_lshl_add_u32 v5, v2, 3, v5
    v_add_u32 v5, 157952, v5
    v_lshrrev_b32 v6, 2, v1
    v_mul_u32_u24 v6, 1152, v6
    v_and_b32 v10, 3, v1
    v_lshl_add_u32 v6, v10, 3, v6
    s_mul_i32 s49, s44, 192
    v_bfe_u32 v10, v1, 3, 2
    v_lshlrev_b32 v10, 5, v10
    v_xor_b32 v16, s49, v10
    v_add_u32 v16, v16, v6
    s_add_u32 s49, s49, 32
    v_xor_b32 v17, s49, v10
    v_add_u32 v17, v17, v6
    s_add_u32 s49, s49, 32
    v_xor_b32 v18, s49, v10
    v_add_u32 v18, v18, v6
    s_add_u32 s49, s49, 32
    v_xor_b32 v19, s49, v10
    v_add_u32 v19, v19, v6
    s_add_u32 s49, s49, 32
    v_xor_b32 v20, s49, v10
    v_add_u32 v20, v20, v6
    s_add_u32 s49, s49, 32
    v_xor_b32 v21, s49, v10
    v_add_u32 v21, v21, v6
    ds_read_b64 v[44:45], v5 offset:0
    ds_read_b64 v[46:47], v5 offset:32
    ds_read_b64 v[48:49], v5 offset:64
    ds_read_b64 v[50:51], v5 offset:96
    v_min_u32 v29, 11, v1
    v_lshlrev_b32 v29, 2, v29
    s_lshr_b32 s69, s18, 2
    s_lshl_b32 s69, s69, 7
    s_add_u32 s69, s69, 65536
    s_mov_b32 s48, 524288
L_B_ms_40:
    buffer_load_dword v28, v29, s[8:11], s69 offen sc1
    s_waitcnt vmcnt(0)
    v_cmp_eq_u32 vcc, v28, v14
    s_nop 1
    s_cmp_eq_u64 vcc, 0
    s_cselect_b64 vcc, -1, 0
    s_cbranch_vccz L_ok_41
    s_sub_u32 s48, s48, 1
    s_cbranch_scc1 L_end
    s_sleep 1
    s_branch L_B_ms_40
L_ok_41:
    s_add_u32 m0, s66, 4096
    s_add_u32 s68, s65, 4096
    v_add_u32 v27, 349536, v24
    v_bfe_u32 v27, v27, 17, 2
    v_lshlrev_b32 v27, 5, v27
    v_xor_b32 v27, v27, v4
    buffer_load_dwordx4 v27, s[28:31], s68 offen offset:2048 nt lds
    v_add_u32 v27, 407792, v24
    v_bfe_u32 v27, v27, 17, 2
    v_lshlrev_b32 v27, 5, v27
    v_xor_b32 v27, v27, v4
    buffer_load_dwordx4 v27, s[28:31], s68 offen offset:3072 nt lds
    s_add_u32 m0, s66, 8192
    s_add_u32 s68, s65, 8192
    v_add_u32 v27, 466048, v24
    v_bfe_u32 v27, v27, 17, 2
    v_lshlrev_b32 v27, 5, v27
    v_xor_b32 v27, v27, v4
    buffer_load_dwordx4 v27, s[28:31], s68 offen offset:0 nt lds
    s_add_u32 m0, s66, 73728
    s_add_u32 s68, s65, 0
    v_add_u32 v27, 0, v24
    v_bfe_u32 v27, v27, 17, 2
    v_lshlrev_b32 v27, 5, v27
    v_xor_b32 v27, v27, v4
    buffer_load_dwordx4 v27, s[32:35], s68 offen offset:0 nt lds
    v_add_u32 v27, 58256, v24
    v_bfe_u32 v27, v27, 17, 2
    v_lshlrev_b32 v27, 5, v27
    v_xor_b32 v27, v27, v4
    buffer_load_dwordx4 v27, s[32:35], s68 offen offset:1024 nt lds
    v_add_u32 v27, 116512, v24
    v_bfe_u32 v27, v27, 17, 2
    v_lshlrev_b32 v27, 5, v27
    v_xor_b32 v27, v27, v4
    buffer_load_dwordx4 v27, s[32:35], s68 offen offset:2048 nt lds
    v_add_u32 v27, 174768, v24
    v_bfe_u32 v27, v27, 17, 2
    v_lshlrev_b32 v27, 5, v27
    v_xor_b32 v27, v27, v4
    buffer_load_dwordx4 v27, s[32:35], s68 offen offset:3072 nt lds
    s_add_u32 m0, s66, 77824
    s_add_u32 s68, s65, 4096
    v_add_u32 v27, 233024, v24
    v_bfe_u32 v27, v27, 17, 2
    v_lshlrev_b32 v27, 5, v27
    v_xor_b32 v27, v27, v4
    buffer_load_dwordx4 v27, s[32:35], s68 offen offset:0 nt lds
    v_add_u32 v27, 291280, v24
    v_bfe_u32 v27, v27, 17, 2
    v_lshlrev_b32 v27, 5, v27
    v_xor_b32 v27, v27, v4
    buffer_load_dwordx4 v27, s[32:35], s68 offen offset:1024 nt lds
    v_add_u32 v27, 349536, v24
    v_bfe_u32 v27, v27, 17, 2
    v_lshlrev_b32 v27, 5, v27
    v_xor_b32 v27, v27, v4
    buffer_load_dwordx4 v27, s[32:35], s68 offen offset:2048 nt lds
    v_add_u32 v27, 407792, v24
    v_bfe_u32 v27, v27, 17, 2
    v_lshlrev_b32 v27, 5, v27
    v_xor_b32 v27, v27, v4
    buffer_load_dwordx4 v27, s[32:35], s68 offen offset:3072 nt lds
    s_add_u32 m0, s66, 81920
    s_add_u32 s68, s65, 8192
    v_add_u32 v27, 466048, v24
    v_bfe_u32 v27, v27, 17, 2
    v_lshlrev_b32 v27, 5, v27
    v_xor_b32 v27, v27, v4
    buffer_load_dwordx4 v27, s[32:35], s68 offen offset:0 nt lds
    s_waitcnt vmcnt(9)
    s_barrier
    ds_read_b64_tr_b16 v[156:157], v16 offset:0
    ds_read_b64_tr_b16 v[158:159], v16 offset:18432
    ds_read_b64_tr_b16 v[160:161], v16 offset:36864
    ds_read_b64_tr_b16 v[162:163], v16 offset:55296
    ds_read_b64_tr_b16 v[164:165], v17 offset:0
    ds_read_b64_tr_b16 v[166:167], v17 offset:18432
    ds_read_b64_tr_b16 v[168:169], v17 offset:36864
    ds_read_b64_tr_b16 v[170:171], v17 offset:55296
    ds_read_b64_tr_b16 v[172:173], v18 offset:0
    ds_read_b64_tr_b16 v[174:175], v18 offset:18432
    ds_read_b64_tr_b16 v[176:177], v18 offset:36864
    ds_read_b64_tr_b16 v[178:179], v18 offset:55296
    ds_read_b64_tr_b16 v[180:181], v19 offset:0
    ds_read_b64_tr_b16 v[182:183], v19 offset:18432
    ds_read_b64_tr_b16 v[184:185], v19 offset:36864
    ds_read_b64_tr_b16 v[186:187], v19 offset:55296
    ds_read_b64_tr_b16 v[188:189], v20 offset:0
    ds_read_b64_tr_b16 v[190:191], v20 offset:18432
    ds_read_b64_tr_b16 v[192:193], v20 offset:36864
    ds_read_b64_tr_b16 v[194:195], v20 offset:55296
    ds_read_b64_tr_b16 v[196:197], v21 offset:0
    ds_read_b64_tr_b16 v[198:199], v21 offset:18432
    ds_read_b64_tr_b16 v[200:201], v21 offset:36864
    ds_read_b64_tr_b16 v[202:203], v21 offset:55296
    v_add_u32 v16, 73728, v16
    v_add_u32 v17, 73728, v17
    v_add_u32 v18, 73728, v18
    v_add_u32 v19, 73728, v19
    v_add_u32 v20, 73728, v20
    v_add_u32 v21, 73728, v21
    s_waitcnt lgkmcnt(0)
    v_mfma_f32_16x16x32_bf16 v[92:95], v[44:47], v[156:159], 0
    v_mfma_f32_16x16x32_bf16 v[96:99], v[44:47], v[164:167], 0
    v_mfma_f32_16x16x32_bf16 v[100:103], v[44:47], v[172:175], 0
    v_mfma_f32_16x16x32_bf16 v[104:107], v[44:47], v[180:183], 0
    v_mfma_f32_16x16x32_bf16 v[108:111], v[44:47], v[188:191], 0
    v_mfma_f32_16x16x32_bf16 v[112:115], v[44:47], v[196:199], 0
    v_mfma_f32_16x16x32_bf16 v[92:95], v[48:51], v[160:163], v[92:95]
    v_mfma_f32_16x16x32_bf16 v[96:99], v[48:51], v[168:171], v[96:99]
    v_mfma_f32_16x16x32_bf16 v[100:103], v[48:51], v[176:179], v[100:103]
    v_mfma_f32_16x16x32_bf16 v[104:107], v[48:51], v[184:187], v[104:107]
    v_mfma_f32_16x16x32_bf16 v[108:111], v[48:51], v[192:195], v[108:111]
    v_mfma_f32_16x16x32_bf16 v[112:115], v[48:51], v[200:203], v[112:115]
    s_waitcnt vmcnt(0)
    s_barrier
    v_lshrrev_b32 v5, 1, v2
    v_lshlrev_b32 v5, 13, v5
    v_and_b32 v6, 31, v1
    v_lshl_add_u32 v30, v6, 2, v5
    s_mul_i32 s50, s44, 49152
    s_lshl_b32 s51, s18, 7
    s_add_u32 s50, s50, s51
    s_add_u32 s50, s50, 917504
    s_add_u32 s51, s50, 16384
    s_add_u32 s52, s50, 32768
    s_mov_b32 s53, 0xff
    v_add_u32 v26, 158464, v4
    ds_read_b64_tr_b16 v[156:157], v16 offset:0
    ds_read_b64_tr_b16 v[158:159], v16 offset:18432
    ds_read_b64_tr_b16 v[160:161], v16 offset:36864
    ds_read_b64_tr_b16 v[162:163], v16 offset:55296
    ds_read_b64_tr_b16 v[164:165], v17 offset:0
    ds_read_b64_tr_b16 v[166:167], v17 offset:18432
    ds_read_b64_tr_b16 v[168:169], v17 offset:36864
    ds_read_b64_tr_b16 v[170:171], v17 offset:55296
    ds_read_b64_tr_b16 v[172:173], v18 offset:0
    ds_read_b64_tr_b16 v[174:175], v18 offset:18432
    ds_read_b64_tr_b16 v[176:177], v18 offset:36864
    ds_read_b64_tr_b16 v[178:179], v18 offset:55296
    ds_read_b64_tr_b16 v[180:181], v19 offset:0
    ds_read_b64_tr_b16 v[182:183], v19 offset:18432
    ds_read_b64_tr_b16 v[184:185], v19 offset:36864
    ds_read_b64_tr_b16 v[186:187], v19 offset:55296
    ds_read_b64_tr_b16 v[188:189], v20 offset:0
    ds_read_b64_tr_b16 v[190:191], v20 offset:18432
    ds_read_b64_tr_b16 v[192:193], v20 offset:36864
    ds_read_b64_tr_b16 v[194:195], v20 offset:55296
    ds_read_b64_tr_b16 v[196:197], v21 offset:0
    ds_read_b64_tr_b16 v[198:199], v21 offset:18432
    ds_read_b64_tr_b16 v[200:201], v21 offset:36864
    ds_read_b64_tr_b16 v[202:203], v21 offset:55296
    s_barrier
    ds_read_b128 v[44:47], v26
    ds_read_b128 v[48:51], v26 offset:1024
    s_waitcnt lgkmcnt(0)
    v_mfma_f32_16x16x32_bf16 v[92:95], v[44:47], v[156:159], v[92:95]
    v_mfma_f32_16x16x32_bf16 v[96:99], v[44:47], v[164:167], v[96:99]
    v_mfma_f32_16x16x32_bf16 v[100:103], v[44:47], v[172:175], v[100:103]
    v_mfma_f32_16x16x32_bf16 v[104:107], v[44:47], v[180:183], v[104:107]
    v_mfma_f32_16x16x32_bf16 v[108:111], v[44:47], v[188:191], v[108:111]
    v_mfma_f32_16x16x32_bf16 v[112:115], v[44:47], v[196:199], v[112:115]
    v_mfma_f32_16x16x32_bf16 v[92:95], v[48:51], v[160:163], v[92:95]
    v_mfma_f32_16x16x32_bf16 v[96:99], v[48:51], v[168:171], v[96:99]
    v_mfma_f32_16x16x32_bf16 v[100:103], v[48:51], v[176:179], v[100:103]
    v_mfma_f32_16x16x32_bf16 v[104:107], v[48:51], v[184:187], v[104:107]
    v_mfma_f32_16x16x32_bf16 v[108:111], v[48:51], v[192:195], v[108:111]
    v_mfma_f32_16x16x32_bf16 v[112:115], v[48:51], v[200:203], v[112:115]
    s_nop 2
    v_pk_add_f32 v[92:93], v[92:93], v[94:95]
    v_pk_add_f32 v[96:97], v[96:97], v[98:99]
    v_pk_add_f32 v[100:101], v[100:101], v[102:103]
    v_pk_add_f32 v[104:105], v[104:105], v[106:107]
    v_pk_add_f32 v[108:109], v[108:109], v[110:111]
    v_pk_add_f32 v[112:113], v[112:113], v[114:115]
    v_permlane32_swap_b32 v92, v96
    v_permlane32_swap_b32 v93, v97
    v_permlane32_swap_b32 v100, v104
    v_permlane32_swap_b32 v101, v105
    v_permlane32_swap_b32 v108, v112
    v_permlane32_swap_b32 v109, v113
    v_add_f32 v92, v92, v96
    v_add_f32 v93, v93, v97
    v_add_f32 v100, v100, v104
    v_add_f32 v101, v101, v105
    v_add_f32 v108, v108, v112
    v_add_f32 v109, v109, v113
    v_permlane16_swap_b32 v92, v93
    v_permlane16_swap_b32 v100, v101
    v_permlane16_swap_b32 v108, v109
    v_add_f32 v92, v92, v93
    v_bfi_b32 v92, s53, v14, v92
    buffer_store_dword v92, v30, s[8:11], s50 offen sc1
    v_add_f32 v100, v100, v101
    v_bfi_b32 v100, s53, v14, v100
    buffer_store_dword v100, v30, s[8:11], s51 offen sc1
    v_add_f32 v108, v108, v109
    v_bfi_b32 v108, s53, v14, v108
    buffer_store_dword v108, v30, s[8:11], s52 offen sc1
    s_branch L_B_done
L_B_red:
    s_cmp_lg_u32 s44, 6
    s_cbranch_scc1 L_B_r7
    v_add_u32 v26, 158464, v4
    v_lshlrev_b32 v11, 3, v3
    v_mov_b32 v5, 1073741824
    v_cmp_gt_u32 s[54:55], 12, v3
    s_nop 1
    v_cndmask_b32 v10, v5, v4, s[54:55]
    v_cndmask_b32 v11, v5, v11, s[54:55]
    v_and_b32 v5, 1, v1
    v_cmp_eq_u32 vcc, 0, v5
    s_nop 1
    v_cndmask_b32 v9, v13, v12, vcc
    v_mov_b32 v30, 0xff800000
    v_and_b32 v31, 0xff, v14
    v_cndmask_b32 v31, 0, v31, s[54:55]
    v_cndmask_b32 v25, 0, v14, s[54:55]
    s_lshl_b32 s49, s59, 12
    s_add_u32 s49, s49, 655360
    s_lshl_b32 s56, s59, 7
    s_add_u32 s56, s56, 98304
    v_min_u32 v29, 11, v1
    v_lshlrev_b32 v29, 2, v29
    s_lshr_b32 s69, s18, 2
    s_lshl_b32 s69, s69, 7
    s_add_u32 s69, s69, 65536
    s_mov_b32 s48, 524288
L_B_ms_42:
    buffer_load_dword v28, v29, s[8:11], s69 offen sc1
    s_waitcnt vmcnt(0)
    v_cmp_eq_u32 vcc, v28, v14
    s_nop 1
    s_cmp_eq_u64 vcc, 0
    s_cselect_b64 vcc, -1, 0
    s_cbranch_vccz L_ok_43
    s_sub_u32 s48, s48, 1
    s_cbranch_scc1 L_end
    s_sleep 1
    s_branch L_B_ms_42
L_ok_43:
    s_add_u32 m0, s66, 4096
    s_add_u32 s68, s65, 4096
    v_add_u32 v27, 349536, v24
    v_bfe_u32 v27, v27, 17, 2
    v_lshlrev_b32 v27, 5, v27
    v_xor_b32 v27, v27, v4
    buffer_load_dwordx4 v27, s[28:31], s68 offen offset:2048 nt lds
    v_add_u32 v27, 407792, v24
    v_bfe_u32 v27, v27, 17, 2
    v_lshlrev_b32 v27, 5, v27
    v_xor_b32 v27, v27, v4
    buffer_load_dwordx4 v27, s[28:31], s68 offen offset:3072 nt lds
    s_add_u32 m0, s66, 8192
    s_add_u32 s68, s65, 8192
    v_add_u32 v27, 466048, v24
    v_bfe_u32 v27, v27, 17, 2
    v_lshlrev_b32 v27, 5, v27
    v_xor_b32 v27, v27, v4
    buffer_load_dwordx4 v27, s[28:31], s68 offen offset:0 nt lds
    s_add_u32 m0, s66, 73728
    s_add_u32 s68, s65, 0
    v_add_u32 v27, 0, v24
    v_bfe_u32 v27, v27, 17, 2
    v_lshlrev_b32 v27, 5, v27
    v_xor_b32 v27, v27, v4
    buffer_load_dwordx4 v27, s[32:35], s68 offen offset:0 nt lds
    v_add_u32 v27, 58256, v24
    v_bfe_u32 v27, v27, 17, 2
    v_lshlrev_b32 v27, 5, v27
    v_xor_b32 v27, v27, v4
    buffer_load_dwordx4 v27, s[32:35], s68 offen offset:1024 nt lds
    v_add_u32 v27, 116512, v24
    v_bfe_u32 v27, v27, 17, 2
    v_lshlrev_b32 v27, 5, v27
    v_xor_b32 v27, v27, v4
    buffer_load_dwordx4 v27, s[32:35], s68 offen offset:2048 nt lds
    v_add_u32 v27, 174768, v24
    v_bfe_u32 v27, v27, 17, 2
    v_lshlrev_b32 v27, 5, v27
    v_xor_b32 v27, v27, v4
    buffer_load_dwordx4 v27, s[32:35], s68 offen offset:3072 nt lds
    s_add_u32 m0, s66, 77824
    s_add_u32 s68, s65, 4096
    v_add_u32 v27, 233024, v24
    v_bfe_u32 v27, v27, 17, 2
    v_lshlrev_b32 v27, 5, v27
    v_xor_b32 v27, v27, v4
    buffer_load_dwordx4 v27, s[32:35], s68 offen offset:0 nt lds
    v_add_u32 v27, 291280, v24
    v_bfe_u32 v27, v27, 17, 2
    v_lshlrev_b32 v27, 5, v27
    v_xor_b32 v27, v27, v4
    buffer_load_dwordx4 v27, s[32:35], s68 offen offset:1024 nt lds
    v_add_u32 v27, 349536, v24
    v_bfe_u32 v27, v27, 17, 2
    v_lshlrev_b32 v27, 5, v27
    v_xor_b32 v27, v27, v4
    buffer_load_dwordx4 v27, s[32:35], s68 offen offset:2048 nt lds
    v_add_u32 v27, 407792, v24
    v_bfe_u32 v27, v27, 17, 2
    v_lshlrev_b32 v27, 5, v27
    v_xor_b32 v27, v27, v4
    buffer_load_dwordx4 v27, s[32:35], s68 offen offset:3072 nt lds
    s_add_u32 m0, s66, 81920
    s_add_u32 s68, s65, 8192
    v_add_u32 v27, 466048, v24
    v_bfe_u32 v27, v27, 17, 2
    v_lshlrev_b32 v27, 5, v27
    v_xor_b32 v27, v27, v4
    buffer_load_dwordx4 v27, s[32:35], s68 offen offset:0 nt lds
    buffer_load_dwordx2 v[32:33], v11, s[8:11], s56 offen sc1
    buffer_load_dwordx4 v[60:63], v10, s[8:11], s49 offen offset:0 sc1
    buffer_load_dwordx4 v[64:67], v10, s[8:11], s49 offen offset:1024 sc1
    buffer_load_dwordx4 v[68:71], v10, s[8:11], s49 offen offset:2048 sc1
    buffer_load_dwordx4 v[72:75], v10, s[8:11], s49 offen offset:3072 sc1
    s_waitcnt vmcnt(14)
    s_barrier
    s_waitcnt vmcnt(5)
    s_barrier
    s_mov_b32 s48, 524288
    s_branch L_B_h6c
L_B_h6:
    buffer_load_dwordx2 v[32:33], v11, s[8:11], s56 offen sc1
    buffer_load_dwordx4 v[60:63], v10, s[8:11], s49 offen offset:0 sc1
    buffer_load_dwordx4 v[64:67], v10, s[8:11], s49 offen offset:1024 sc1
    buffer_load_dwordx4 v[68:71], v10, s[8:11], s49 offen offset:2048 sc1
    buffer_load_dwordx4 v[72:75], v10, s[8:11], s49 offen offset:3072 sc1
L_B_h6c:
    s_waitcnt vmcnt(0)
    v_cmp_ne_u32 s[70:71], v33, v25
    v_xor_b32 v60, v31, v60
    v_xor_b32 v61, v31, v61
    v_xor_b32 v62, v31, v62
    v_xor_b32 v63, v31, v63
    v_xor_b32 v64, v31, v64
    v_xor_b32 v65, v31, v65
    v_xor_b32 v66, v31, v66
    v_xor_b32 v67, v31, v67
    v_xor_b32 v68, v31, v68
    v_xor_b32 v69, v31, v69
    v_xor_b32 v70, v31, v70
    v_xor_b32 v71, v31, v71
    v_xor_b32 v72, v31, v72
    v_xor_b32 v73, v31, v73
    v_xor_b32 v74, v31, v74
    v_xor_b32 v75, v31, v75
    v_or3_b32 v6, v60, v61, v62
    v_or3_b32 v40, v63, v64, v65
    v_or3_b32 v6, v6, v66, v67
    v_or3_b32 v40, v40, v68, v69
    v_or3_b32 v6, v6, v70, v71
    v_or3_b32 v40, v40, v72, v73
    v_or3_b32 v6, v6, v74, v75
    v_or_b32 v6, v6, v40
    v_and_b32 v6, 0xff, v6
    v_cmp_ne_u32 vcc, 0, v6
    s_nop 1
    s_or_b64 vcc, vcc, s[70:71]
    s_cbranch_vccz L_ok_44
    s_sub_u32 s48, s48, 1
    s_cbranch_scc1 L_end
    s_branch L_B_h6
L_ok_44:
    v_cndmask_b32 v28, v30, v32, s[54:55]
    s_nop 1
    v_max_f32_dpp v5, v28, v28 row_ror:2 row_mask:0xf bank_mask:0xf
    s_nop 1
    v_max_f32_dpp v5, v5, v5 row_ror:4 row_mask:0xf bank_mask:0xf
    s_nop 1
    v_max_f32_dpp v5, v5, v5 row_ror:8 row_mask:0xf bank_mask:0xf
    v_sub_f32 v28, v28, v5
    v_exp_f32 v28, v28
    s_nop 1
    v_add_f32_dpp v5, v28, v28 row_ror:2 row_mask:0xf bank_mask:0xf
    s_nop 1
    v_add_f32_dpp v5, v5, v5 row_ror:4 row_mask:0xf bank_mask:0xf
    s_nop 1
    v_add_f32_dpp v5, v5, v5 row_ror:8 row_mask:0xf bank_mask:0xf
    v_rcp_f32 v5, v5
    v_mul_f32 v28, v28, v9
    v_mul_f32 v28, v28, v5
    v_pk_mul_f32 v[60:61], v[28:29], v[60:61] op_sel_hi:[0,1]
    v_cvt_pk_bf16_f32 v44, v60, v61
    v_pk_mul_f32 v[62:63], v[28:29], v[62:63] op_sel_hi:[0,1]
    v_cvt_pk_bf16_f32 v45, v62, v63
    v_pk_mul_f32 v[64:65], v[28:29], v[64:65] op_sel_hi:[0,1]
    v_cvt_pk_bf16_f32 v46, v64, v65
    v_pk_mul_f32 v[66:67], v[28:29], v[66:67] op_sel_hi:[0,1]
    v_cvt_pk_bf16_f32 v47, v66, v67
    v_pk_mul_f32 v[68:69], v[28:29], v[68:69] op_sel_hi:[0,1]
    v_cvt_pk_bf16_f32 v48, v68, v69
    v_pk_mul_f32 v[70:71], v[28:29], v[70:71] op_sel_hi:[0,1]
    v_cvt_pk_bf16_f32 v49, v70, v71
    v_pk_mul_f32 v[72:73], v[28:29], v[72:73] op_sel_hi:[0,1]
    v_cvt_pk_bf16_f32 v50, v72, v73
    v_pk_mul_f32 v[74:75], v[28:29], v[74:75] op_sel_hi:[0,1]
    v_cvt_pk_bf16_f32 v51, v74, v75
    ds_write_b128 v26, v[44:47]
    ds_write_b128 v26, v[48:51] offset:1024
    s_waitcnt lgkmcnt(0)
    s_barrier
    s_branch L_B_r6
L_B_r7:
    v_min_u32 v29, 11, v1
    v_lshlrev_b32 v29, 2, v29
    s_lshr_b32 s69, s18, 2
    s_lshl_b32 s69, s69, 7
    s_add_u32 s69, s69, 65536
    s_mov_b32 s48, 524288
L_B_ms_45:
    buffer_load_dword v28, v29, s[8:11], s69 offen sc1
    s_waitcnt vmcnt(0)
    v_cmp_eq_u32 vcc, v28, v14
    s_nop 1
    s_cmp_eq_u64 vcc, 0
    s_cselect_b64 vcc, -1, 0
    s_cbranch_vccz L_ok_46
    s_sub_u32 s48, s48, 1
    s_cbranch_scc1 L_end
    s_sleep 1
    s_branch L_B_ms_45
L_ok_46:
    s_add_u32 m0, s66, 4096
    s_add_u32 s68, s65, 4096
    v_add_u32 v27, 349536, v24
    v_bfe_u32 v27, v27, 17, 2
    v_lshlrev_b32 v27, 5, v27
    v_xor_b32 v27, v27, v4
    buffer_load_dwordx4 v27, s[28:31], s68 offen offset:2048 nt lds
    v_add_u32 v27, 407792, v24
    v_bfe_u32 v27, v27, 17, 2
    v_lshlrev_b32 v27, 5, v27
    v_xor_b32 v27, v27, v4
    buffer_load_dwordx4 v27, s[28:31], s68 offen offset:3072 nt lds
    s_add_u32 m0, s66, 8192
    s_add_u32 s68, s65, 8192
    v_add_u32 v27, 466048, v24
    v_bfe_u32 v27, v27, 17, 2
    v_lshlrev_b32 v27, 5, v27
    v_xor_b32 v27, v27, v4
    buffer_load_dwordx4 v27, s[28:31], s68 offen offset:0 nt lds
    s_add_u32 m0, s66, 73728
    s_add_u32 s68, s65, 0
    v_add_u32 v27, 0, v24
    v_bfe_u32 v27, v27, 17, 2
    v_lshlrev_b32 v27, 5, v27
    v_xor_b32 v27, v27, v4
    buffer_load_dwordx4 v27, s[32:35], s68 offen offset:0 nt lds
    v_add_u32 v27, 58256, v24
    v_bfe_u32 v27, v27, 17, 2
    v_lshlrev_b32 v27, 5, v27
    v_xor_b32 v27, v27, v4
    buffer_load_dwordx4 v27, s[32:35], s68 offen offset:1024 nt lds
    v_add_u32 v27, 116512, v24
    v_bfe_u32 v27, v27, 17, 2
    v_lshlrev_b32 v27, 5, v27
    v_xor_b32 v27, v27, v4
    buffer_load_dwordx4 v27, s[32:35], s68 offen offset:2048 nt lds
    v_add_u32 v27, 174768, v24
    v_bfe_u32 v27, v27, 17, 2
    v_lshlrev_b32 v27, 5, v27
    v_xor_b32 v27, v27, v4
    buffer_load_dwordx4 v27, s[32:35], s68 offen offset:3072 nt lds
    s_add_u32 m0, s66, 77824
    s_add_u32 s68, s65, 4096
    v_add_u32 v27, 233024, v24
    v_bfe_u32 v27, v27, 17, 2
    v_lshlrev_b32 v27, 5, v27
    v_xor_b32 v27, v27, v4
    buffer_load_dwordx4 v27, s[32:35], s68 offen offset:0 nt lds
    v_add_u32 v27, 291280, v24
    v_bfe_u32 v27, v27, 17, 2
    v_lshlrev_b32 v27, 5, v27
    v_xor_b32 v27, v27, v4
    buffer_load_dwordx4 v27, s[32:35], s68 offen offset:1024 nt lds
    v_add_u32 v27, 349536, v24
    v_bfe_u32 v27, v27, 17, 2
    v_lshlrev_b32 v27, 5, v27
    v_xor_b32 v27, v27, v4
    buffer_load_dwordx4 v27, s[32:35], s68 offen offset:2048 nt lds
    v_add_u32 v27, 407792, v24
    v_bfe_u32 v27, v27, 17, 2
    v_lshlrev_b32 v27, 5, v27
    v_xor_b32 v27, v27, v4
    buffer_load_dwordx4 v27, s[32:35], s68 offen offset:3072 nt lds
    s_add_u32 m0, s66, 81920
    s_add_u32 s68, s65, 8192
    v_add_u32 v27, 466048, v24
    v_bfe_u32 v27, v27, 17, 2
    v_lshlrev_b32 v27, 5, v27
    v_xor_b32 v27, v27, v4
    buffer_load_dwordx4 v27, s[32:35], s68 offen offset:0 nt lds
    s_waitcnt vmcnt(9)
    s_barrier
    s_waitcnt vmcnt(0)
    s_barrier
    s_barrier
L_B_r6:
    s_cmp_ge_u32 s18, 36
    s_cbranch_scc1 L_B_done
    s_sub_u32 s49, s44, 6
    s_lshl_b32 s50, s18, 13
    s_lshl_b32 s51, s49, 6
    s_add_u32 s50, s50, s51
    s_add_u32 s50, s50, 917504
    s_add_u32 s56, s50, 4096
    s_mul_i32 s49, s49, 36
    s_add_u32 s49, s49, s18
    v_lshrrev_b32 v5, 2, v1
    v_lshlrev_b32 v5, 7, v5
    v_and_b32 v6, 3, v1
    v_lshl_add_u32 v4, v6, 4, v5
    s_lshl_b32 s51, s49, 5
    v_and_b32 v5, 3, v1
    v_lshlrev_b32 v5, 2, v5
    v_and_b32 v6, 1, v2
    v_lshl_add_u32 v5, v6, 1, v5
    v_lshrrev_b32 v6, 1, v2
    v_add_lshl_u32 v10, v5, v6, 1
    v_and_b32 v31, 0xff, v14
    s_mov_b32 s48, 524288
    buffer_load_dwordx4 v[156:159], v4, s[8:11], s50 offen offset:0 sc1
    buffer_load_dwordx4 v[160:163], v4, s[8:11], s50 offen offset:2048 sc1
    buffer_load_dwordx4 v[164:167], v4, s[8:11], s56 offen offset:0 sc1
    buffer_load_dwordx4 v[168:171], v4, s[8:11], s56 offen offset:2048 sc1
    buffer_load_dwordx4 v[172:175], v4, s[8:11], s50 offen offset:0 sc1
    buffer_load_dwordx4 v[176:179], v4, s[8:11], s50 offen offset:2048 sc1
    buffer_load_dwordx4 v[180:183], v4, s[8:11], s56 offen offset:0 sc1
    buffer_load_dwordx4 v[184:187], v4, s[8:11], s56 offen offset:2048 sc1
L_B_h2:
    s_waitcnt vmcnt(4)
    v_xor_b32 v156, v31, v156
    v_xor_b32 v157, v31, v157
    v_xor_b32 v158, v31, v158
    v_xor_b32 v159, v31, v159
    v_xor_b32 v160, v31, v160
    v_xor_b32 v161, v31, v161
    v_xor_b32 v162, v31, v162
    v_xor_b32 v163, v31, v163
    v_xor_b32 v164, v31, v164
    v_xor_b32 v165, v31, v165
    v_xor_b32 v166, v31, v166
    v_xor_b32 v167, v31, v167
    v_xor_b32 v168, v31, v168
    v_xor_b32 v169, v31, v169
    v_xor_b32 v170, v31, v170
    v_xor_b32 v171, v31, v171
    v_or3_b32 v6, v156, v157, v158
    v_or3_b32 v40, v159, v160, v161
    v_or3_b32 v6, v6, v162, v163
    v_or3_b32 v40, v40, v164, v165
    v_or3_b32 v6, v6, v166, v167
    v_or3_b32 v40, v40, v168, v169
    v_or3_b32 v6, v6, v170, v171
    v_or_b32 v6, v6, v40
    v_and_b32 v6, 0xff, v6
    v_cmp_ne_u32 vcc, 0, v6
    s_nop 1
    s_cbranch_vccz L_B_h2_a0
    buffer_load_dwordx4 v[156:159], v4, s[8:11], s50 offen offset:0 sc1
    buffer_load_dwordx4 v[160:163], v4, s[8:11], s50 offen offset:2048 sc1
    buffer_load_dwordx4 v[164:167], v4, s[8:11], s56 offen offset:0 sc1
    buffer_load_dwordx4 v[168:171], v4, s[8:11], s56 offen offset:2048 sc1
    s_waitcnt vmcnt(4)
    v_xor_b32 v172, v31, v172
    v_xor_b32 v173, v31, v173
    v_xor_b32 v174, v31, v174
    v_xor_b32 v175, v31, v175
    v_xor_b32 v176, v31, v176
    v_xor_b32 v177, v31, v177
    v_xor_b32 v178, v31, v178
    v_xor_b32 v179, v31, v179
    v_xor_b32 v180, v31, v180
    v_xor_b32 v181, v31, v181
    v_xor_b32 v182, v31, v182
    v_xor_b32 v183, v31, v183
    v_xor_b32 v184, v31, v184
    v_xor_b32 v185, v31, v185
    v_xor_b32 v186, v31, v186
    v_xor_b32 v187, v31, v187
    v_or3_b32 v6, v172, v173, v174
    v_or3_b32 v40, v175, v176, v177
    v_or3_b32 v6, v6, v178, v179
    v_or3_b32 v40, v40, v180, v181
    v_or3_b32 v6, v6, v182, v183
    v_or3_b32 v40, v40, v184, v185
    v_or3_b32 v6, v6, v186, v187
    v_or_b32 v6, v6, v40
    v_and_b32 v6, 0xff, v6
    v_cmp_ne_u32 vcc, 0, v6
    s_nop 1
    s_cbranch_vccz L_B_h2_a1
    buffer_load_dwordx4 v[172:175], v4, s[8:11], s50 offen offset:0 sc1
    buffer_load_dwordx4 v[176:179], v4, s[8:11], s50 offen offset:2048 sc1
    buffer_load_dwordx4 v[180:183], v4, s[8:11], s56 offen offset:0 sc1
    buffer_load_dwordx4 v[184:187], v4, s[8:11], s56 offen offset:2048 sc1
    s_sub_u32 s48, s48, 1
    s_cbranch_scc0 L_B_h2
    s_branch L_end
L_B_h2_a0:
    v_add_f32 v60, v156, v160
    v_add_f32 v68, v164, v168
    v_add_f32 v61, v157, v161
    v_add_f32 v69, v165, v169
    v_add_f32 v62, v158, v162
    v_add_f32 v70, v166, v170
    v_add_f32 v63, v159, v163
    v_add_f32 v71, v167, v171
    s_branch L_B_h2_z
L_B_h2_a1:
    v_add_f32 v60, v172, v176
    v_add_f32 v68, v180, v184
    v_add_f32 v61, v173, v177
    v_add_f32 v69, v181, v185
    v_add_f32 v62, v174, v178
    v_add_f32 v70, v182, v186
    v_add_f32 v63, v175, v179
    v_add_f32 v71, v183, v187
L_B_h2_z:
    v_add_f32 v60, v60, v68
    v_add_f32 v61, v61, v69
    v_add_f32 v62, v62, v70
    v_add_f32 v63, v63, v71
    v_permlane32_swap_b32 v60, v61
    s_nop 0
    v_permlane32_swap_b32 v62, v63
    v_add_f32 v60, v60, v61
    v_add_f32 v62, v62, v63
    s_nop 1
    v_permlane16_swap_b32 v60, v62
    v_add_f32 v60, v60, v62
    s_nop 1
    v_add_f32_dpp v60, v60, v60 row_ror:4 row_mask:0xf bank_mask:0xf
    s_nop 1
    v_add_f32_dpp v60, v60, v60 row_ror:8 row_mask:0xf bank_mask:0xf
    v_cvt_pk_bf16_f32 v60, v60, v60
    buffer_store_short v60, v10, s[12:15], s51 offen
    s_cmp_lg_u32 s49, 0
    s_cbranch_scc1 L_B_done
    v_mov_b32 v5, 0
    s_mov_b64 exec, 1
    buffer_store_dword v14, v5, s[8:11], 0 offen sc1
    s_mov_b64 exec, -1
L_B_done:
L_end:
    s_endpgm
L_codeend:

.section .rodata,"a"
.p2align 6
.amdhsa_kernel gated_mix__gqa_block_cached__compressed_kv_cla__decode_kernel
  .amdhsa_next_free_vgpr 256
  .amdhsa_next_free_sgpr 102
  .amdhsa_accum_offset 256
  .amdhsa_group_segment_fixed_size 0
  .amdhsa_kernarg_size 120
  .amdhsa_user_sgpr_count 2
  .amdhsa_user_sgpr_kernarg_segment_ptr 1
  .amdhsa_system_sgpr_workgroup_id_x 1
  .amdhsa_float_denorm_mode_32 3
.end_amdhsa_kernel
```
